```python
import torch

def _softmax(x, axis=-1):
    return torch.softmax(x, dim=axis)

def _gelu(x):
    return torch.nn.functional.gelu(x, approximate='tanh')

def _silu(x):
    return torch.nn.functional.silu(x)

def _sigmoid(x):
    return torch.sigmoid(x)

def _layernorm(x, axis=-1, eps=1e-05):
    m = x.mean(dim=axis, keepdim=True)
    v = x.var(dim=axis, keepdim=True, unbiased=False)
    return (x - m) / torch.sqrt(v + eps)

def _scatter_add(tgt, idx, src, axis=0):
    return tgt.clone().index_add_(axis, idx, src)

def _segment_sum(src, seg, n):
    out = torch.zeros((n,) + src.shape[1:], dtype=src.dtype)
    return out.index_add_(0, seg, src)

def _pad(x, pw):
    flat = tuple((v for pair in reversed(pw) for v in pair))
    return torch.nn.functional.pad(x, flat)
kernel_name = 'adaLN_cond__gqa_block_cached__swiglu_ffn__decode'

def setup_inputs():

    _w = lambda a: (lambda t: t.to(torch.bfloat16) if t.is_floating_point() else t)(torch.as_tensor(a))

    def _A_setup():
        B, Sq, D = (1, 1, 1024)
        Hq, Hkv, Sk, Dh = (32, 4, 65536, 128)
        assert Hq % Hkv == 0, (Hq, Hkv)
        return {'x': _w((lambda *s: torch.randn(*s, dtype=torch.bfloat16) * 0.05)(B, Sq, D)), 'k_cache': _w((lambda *s: torch.randn(*s, dtype=torch.bfloat16) * 3.2)(B, Hkv, Sk, Dh)), 'v_cache': _w((lambda *s: torch.randn(*s, dtype=torch.bfloat16) * 0.4)(B, Hkv, Sk, Dh)), 'wq': _w((lambda *s: torch.randn(*s, dtype=torch.bfloat16) * 3.2)(D, Hq * Dh) * D ** (-0.5)), 'wo': _w((lambda *s: torch.randn(*s, dtype=torch.bfloat16) * 0.4)(Hq * Dh, D) * (Hq * Dh) ** (-0.5))}
    _A_in = _A_setup()

    def _B_setup():
        B, S, D, F = (1, 1, 1024, 3584)
        return {'x': _w((lambda *s: torch.randn(*s, dtype=torch.bfloat16) * 0.05)(B, S, D)), 'w_gate': _w((lambda *s: torch.randn(*s, dtype=torch.bfloat16) * 0.05)(D, F)), 'w_up': _w((lambda *s: torch.randn(*s, dtype=torch.bfloat16) * 0.05)(D, F)), 'w_down': _w((lambda *s: torch.randn(*s, dtype=torch.bfloat16) * 0.05)(F, D))}
    _B_in = _B_setup()
    return {'A_x': _A_in['x'], 'A_k_cache': _A_in['k_cache'], 'A_v_cache': _A_in['v_cache'], 'A_wq': _A_in['wq'], 'A_wo': _A_in['wo'], 'B_x': _B_in['x'], 'B_w_gate': _B_in['w_gate'], 'B_w_up': _B_in['w_up'], 'B_w_down': _B_in['w_down'], 'c': _w((lambda *s: torch.randn(*s, dtype=torch.bfloat16) * 0.4)(1, 1024) * 8.0), 'w_mod': _w((lambda *s: torch.randn(*s, dtype=torch.bfloat16) * 0.4)(1024, 6 * 1024) * 1024 ** (-0.5) * 8.0)}

def reference(A_x, A_k_cache, A_v_cache, A_wq, A_wo, B_x, B_w_gate, B_w_up, B_w_down, c, w_mod):

    def _A_ref(x, k_cache, v_cache, wq, wo):
        B, Sq, D = x.shape
        Hq, Dh = (32, 128)
        Hkv = k_cache.shape[1]
        rep = Hq // Hkv
        q = (lambda x, *d: x.permute(*d))((x @ wq).reshape(B, Sq, Hq, Dh), 0, 2, 1, 3)
        k = (lambda x, n, axis: torch.repeat_interleave(x, n, dim=axis))(k_cache, rep, axis=1)
        v = (lambda x, n, axis: torch.repeat_interleave(x, n, dim=axis))(v_cache, rep, axis=1)
        scores = torch.einsum('bhqd,bhkd->bhqk', q, k) * Dh ** (-0.5)
        p = _softmax(scores, axis=-1)
        o = torch.einsum('bhqk,bhkd->bhqd', p, v)
        return (lambda x, *d: x.permute(*d))(o, 0, 2, 1, 3).reshape(B, Sq, Hq * Dh) @ wo

    def _B_ref(x, w_gate, w_up, w_down):
        g = _silu(x @ w_gate)
        u = x @ w_up
        return g * u @ w_down
    x = A_x
    mod = (_silu(c) @ w_mod).reshape(c.shape[0], 6, 1, -1)
    sa, ca, ga, sb, cb, gb = (mod[:, 0].clone(), mod[:, 1].clone(), mod[:, 2].clone(), mod[:, 3].clone(), mod[:, 4].clone(), mod[:, 5].clone())
    h = _layernorm(x, axis=-1) * (1 + ca) + sa
    x = x + ga * _A_ref(h, A_k_cache, A_v_cache, A_wq, A_wo)
    h = _layernorm(x, axis=-1) * (1 + cb) + sb
    x = x + gb * _B_ref(h, B_w_gate, B_w_up, B_w_down)
    return x
```

```asm
; @launch grid=(256,1,1) block=(768,1,1) lds=141568
.amdgcn_target "amdgcn-amd-amdhsa--gfx950"
.text
.globl adaLN_cond__gqa_block_cached__swiglu_ffn__decode_kernel
.p2align 8
.type adaLN_cond__gqa_block_cached__swiglu_ffn__decode_kernel,@function
adaLN_cond__gqa_block_cached__swiglu_ffn__decode_kernel:
s_load_dwordx16 s[4:19], s[0:1], 0
v_lshrrev_b32 v2, 6, v0
v_and_b32 v33, 15, v0
s_lshr_b32 s92, s2, 8
v_readfirstlane_b32 s3, v2
s_cbranch_scc1 L_end
s_load_dwordx8 s[20:27], s[0:1], 64
s_load_dwordx4 s[28:31], s[0:1], 96
v_bfe_u32 v32, v0, 4, 2
s_sub_u32 s3, s3, 4
s_cbranch_scc1 L_chain
v_lshl_or_b32 v34, v33, 2, v33
v_and_b32 v34, 0x33, v34
v_lshl_or_b32 v34, v34, 1, v34
v_and_b32 v34, 0x55, v34
v_lshlrev_b32 v2, 4, v32
v_lshl_add_u32 v2, v34, 6, v2
s_lshr_b32 s92, s2, 2
s_lshl3_add_u32 s92, s92, s3
s_lshl_b32 s92, s92, 13
s_and_b32 s84, s2, 3
s_lshl_b32 s86, s84, 24
s_add_u32 s86, s86, s92
s_mov_b32 s34, 67108864
s_mov_b32 s35, 0x20000
s_lshl_b32 s94, s3, 8
s_add_u32 s94, s94, s2
s_cmp_lt_u32 s94, 16
s_waitcnt lgkmcnt(0)
s_cbranch_scc1 L_early
L_early_done:
s_mov_b32 s32, s6
s_and_b32 s33, s7, 0xffff
s_add_u32 s95, s86, 0
buffer_load_dwordx4 v[40:43], v2, s[32:35], s95 offen offset:0 nt
buffer_load_dwordx4 v[44:47], v2, s[32:35], s95 offen offset:128 nt
buffer_load_dwordx4 v[48:51], v2, s[32:35], s95 offen offset:512 nt
s_branch L_a1
L_early:
s_setprio 3
s_mov_b32 s64, s30
s_and_b32 s65, s31, 0xffff
s_mov_b32 s66, 268435456
s_mov_b32 s67, 0x20000
s_mov_b32 s80, s28
s_and_b32 s81, s29, 0xffff
s_mov_b32 s82, 256
s_mov_b32 s83, 0x20000
v_and_b32 v1, 63, v0
v_lshlrev_b32 v39, 4, v1
v_mov_b32 v28, -1
v_mov_b32 v29, -1
v_mov_b32 v30, -1
v_mov_b32 v31, -1
s_mul_i32 s93, s2, 11264
buffer_store_dwordx4 v[28:31], v39, s[64:67], s93 offen offset:0 sc1
buffer_store_dwordx4 v[28:31], v39, s[64:67], s93 offen offset:1024 sc1
buffer_store_dwordx4 v[28:31], v39, s[64:67], s93 offen offset:2048 sc1
buffer_store_dwordx4 v[28:31], v39, s[64:67], s93 offen offset:3072 sc1
s_add_u32 s93, s93, 4096
buffer_store_dwordx4 v[28:31], v39, s[64:67], s93 offen offset:0 sc1
buffer_store_dwordx4 v[28:31], v39, s[64:67], s93 offen offset:1024 sc1
buffer_store_dwordx4 v[28:31], v39, s[64:67], s93 offen offset:2048 sc1
buffer_store_dwordx4 v[28:31], v39, s[64:67], s93 offen offset:3072 sc1
s_add_u32 s93, s93, 4096
buffer_store_dwordx4 v[28:31], v39, s[64:67], s93 offen offset:0 sc1
buffer_store_dwordx4 v[28:31], v39, s[64:67], s93 offen offset:1024 sc1
buffer_store_dwordx4 v[28:31], v39, s[64:67], s93 offen offset:2048 sc1
v_lshlrev_b32 v38, 6, v1
v_mov_b32 v6, 1
s_mov_b64 exec, 15
s_waitcnt vmcnt(0)
buffer_atomic_add v6, v38, s[80:83], 0 offen sc1
s_mov_b64 exec, -1
s_branch L_early_done
L_a1:
v_and_b32 v1, 63, v0
v_mov_b32 v5, 138240
v_mov_b32 v6, 1
s_and_b32 s87, s2, 7
s_bfe_u32 s88, s2, 0x30003
s_bfe_u32 s85, s2, 0x40003
s_lshr_b32 s89, s2, 7
s_mov_b32 s66, 268435456
s_mov_b32 s67, 0x20000
s_mov_b32 s70, 2048
s_mov_b32 s71, 0x20000
s_mov_b32 s38, 67108864
s_mov_b32 s39, 0x20000
s_add_u32 s91, s3, 4
s_mov_b32 s64, s30
s_and_b32 s65, s31, 0xffff
s_mov_b32 s36, s8
s_and_b32 s37, s9, 0xffff
s_mov_b32 s68, s4
s_and_b32 s69, s5, 0xffff
s_cmp_lg_u32 s89, 0
s_cselect_b32 s44, s12, s16
s_cselect_b32 s45, s13, s17
s_mov_b32 s46, 7340032
s_cselect_b32 s46, 8388608, s46
s_and_b32 s45, s45, 0xffff
s_mov_b32 s47, 0x20000
s_mov_b32 s52, s18
s_and_b32 s53, s19, 0xffff
s_mov_b32 s54, 7340032
s_mov_b32 s55, 0x20000
s_mov_b32 s56, s20
s_and_b32 s57, s21, 0xffff
s_mov_b32 s58, 7340032
s_mov_b32 s59, 0x20000
s_mov_b32 s76, s26
s_and_b32 s77, s27, 0xffff
s_mov_b32 s78, 2048
s_mov_b32 s79, 0x20000
s_mov_b32 s23, s91
v_lshlrev_b32 v34, 1, v32
v_xor_b32 v34, v34, v33
v_lshlrev_b32 v34, 4, v34
v_lshl_add_u32 v3, v32, 8, v34
v_lshlrev_b32 v34, 1, v32
v_add_u32 v34, 8, v34
v_xor_b32 v34, v34, v33
v_lshlrev_b32 v34, 4, v34
v_lshl_add_u32 v4, v32, 8, v34
s_lshl_b32 s4, s3, 14
s_setprio 3
s_add_u32 s95, s86, 0
s_waitcnt vmcnt(2)
buffer_load_dwordx4 v[52:55], v2, s[32:35], s95 offen offset:640 nt
s_waitcnt vmcnt(2)
buffer_load_dwordx4 v[56:59], v2, s[32:35], s95 offen offset:2048 nt
s_waitcnt vmcnt(2)
buffer_load_dwordx4 v[60:63], v2, s[32:35], s95 offen offset:2176 nt
s_cmp_lg_u32 s3, 0
s_cbranch_scc1 L_noinit_1
v_mov_b32 v12, 0
v_lshl_add_u32 v13, v1, 2, v5
s_mov_b64 exec, 0xffff
ds_write_b32 v13, v12
s_mov_b64 exec, -1
s_waitcnt lgkmcnt(0)
L_noinit_1:
s_barrier
s_mov_b32 s21, 0
s_mul_i32 s22, s88, 1792
s_add_u32 s22, s22, 163840
s_add_u32 s95, s86, 0
s_waitcnt vmcnt(2)
buffer_load_dwordx4 v[64:67], v2, s[32:35], s95 offen offset:2560 nt
s_waitcnt vmcnt(2)
buffer_load_dwordx4 v[68:71], v2, s[32:35], s95 offen offset:2688 nt
s_mov_b64 exec, 1
ds_add_rtn_u32 v20, v5, v6 offset:40
ds_read_b32 v0, v5 offset:48
ds_read_b32 v19, v5 offset:4
s_waitcnt lgkmcnt(0)
v_readfirstlane_b32 s93, v20
v_readfirstlane_b32 s92, v0
s_and_b32 s94, s93, 15
s_cmp_lg_u32 s94, 0
s_cbranch_scc1 L_nt_5
v_cmp_eq_u32 vcc, 0, v19
s_cbranch_vccnz L_nt_5
s_lshl_b32 s94, s93, 4
s_add_u32 s94, s94, s22
v_mov_b32 v21, 1
s_mov_b32 s21, 1
buffer_atomic_add v21, off, s[64:67], s94 sc0 sc1
L_nt_5:
s_mov_b64 exec, -1
s_cmp_ge_u32 s93, 6
s_cbranch_scc1 L_lv_3
s_cmp_gt_u32 s92, 20
s_cbranch_scc1 L_lv_3
s_sub_u32 s92, s92, 1
s_cmp_ge_u32 s92, 8
s_cbranch_scc1 L_lv_2
s_add_u32 s95, s86, 4194304
s_waitcnt vmcnt(1)
buffer_load_dwordx4 v[72:75], v2, s[32:35], s95 offen offset:0 nt
s_waitcnt vmcnt(1)
buffer_load_dwordx4 v[76:79], v2, s[32:35], s95 offen offset:128 nt
s_waitcnt vmcnt(1)
buffer_load_dwordx4 v[80:83], v2, s[32:35], s95 offen offset:512 nt
s_waitcnt vmcnt(1)
buffer_load_dwordx4 v[84:87], v2, s[32:35], s95 offen offset:640 nt
s_branch L_lve_4
L_lv_2:
s_add_u32 s95, s86, 4194304
s_waitcnt vmcnt(2)
buffer_load_dwordx4 v[72:75], v2, s[32:35], s95 offen offset:0 nt
s_waitcnt vmcnt(2)
buffer_load_dwordx4 v[76:79], v2, s[32:35], s95 offen offset:128 nt
s_waitcnt vmcnt(2)
buffer_load_dwordx4 v[80:83], v2, s[32:35], s95 offen offset:512 nt
s_waitcnt vmcnt(2)
buffer_load_dwordx4 v[84:87], v2, s[32:35], s95 offen offset:640 nt
s_branch L_lve_4
L_lv_3:
s_add_u32 s95, s86, 4194304
s_waitcnt vmcnt(4)
buffer_load_dwordx4 v[72:75], v2, s[32:35], s95 offen offset:0 nt
s_waitcnt vmcnt(4)
buffer_load_dwordx4 v[76:79], v2, s[32:35], s95 offen offset:128 nt
s_waitcnt vmcnt(4)
buffer_load_dwordx4 v[80:83], v2, s[32:35], s95 offen offset:512 nt
s_waitcnt vmcnt(4)
buffer_load_dwordx4 v[84:87], v2, s[32:35], s95 offen offset:640 nt
L_lve_4:
s_mov_b64 exec, 1
s_cmp_eq_u32 s21, 0
s_cbranch_scc1 L_fl_10
s_mov_b32 s21, 0
s_waitcnt vmcnt(4)
v_add_u32 v21, 2, v21
ds_write_b32 v5, v21 offset:48
L_fl_10:
ds_add_rtn_u32 v20, v5, v6 offset:40
ds_read_b32 v0, v5 offset:48
ds_read_b32 v19, v5 offset:4
s_waitcnt lgkmcnt(0)
v_readfirstlane_b32 s93, v20
v_readfirstlane_b32 s92, v0
s_and_b32 s94, s93, 15
s_cmp_lg_u32 s94, 0
s_cbranch_scc1 L_nt_9
v_cmp_eq_u32 vcc, 0, v19
s_cbranch_vccnz L_nt_9
s_lshl_b32 s94, s93, 4
s_add_u32 s94, s94, s22
v_mov_b32 v21, 1
s_mov_b32 s21, 1
buffer_atomic_add v21, off, s[64:67], s94 sc0 sc1
L_nt_9:
s_mov_b64 exec, -1
s_cmp_ge_u32 s93, 14
s_cbranch_scc1 L_lv_7
s_cmp_gt_u32 s92, 20
s_cbranch_scc1 L_lv_7
s_sub_u32 s92, s92, 1
s_cmp_ge_u32 s92, 8
s_cbranch_scc1 L_lv_6
s_add_u32 s95, s86, 4194304
s_waitcnt vmcnt(1)
buffer_load_dwordx4 v[88:91], v2, s[32:35], s95 offen offset:2048 nt
s_waitcnt vmcnt(1)
buffer_load_dwordx4 v[92:95], v2, s[32:35], s95 offen offset:2176 nt
s_waitcnt vmcnt(1)
buffer_load_dwordx4 v[96:99], v2, s[32:35], s95 offen offset:2560 nt
s_waitcnt vmcnt(1)
buffer_load_dwordx4 v[100:103], v2, s[32:35], s95 offen offset:2688 nt
s_branch L_lve_8
L_lv_6:
s_add_u32 s95, s86, 4194304
s_waitcnt vmcnt(2)
buffer_load_dwordx4 v[88:91], v2, s[32:35], s95 offen offset:2048 nt
s_waitcnt vmcnt(2)
buffer_load_dwordx4 v[92:95], v2, s[32:35], s95 offen offset:2176 nt
s_waitcnt vmcnt(2)
buffer_load_dwordx4 v[96:99], v2, s[32:35], s95 offen offset:2560 nt
s_waitcnt vmcnt(2)
buffer_load_dwordx4 v[100:103], v2, s[32:35], s95 offen offset:2688 nt
s_branch L_lve_8
L_lv_7:
s_add_u32 s95, s86, 4194304
s_waitcnt vmcnt(4)
buffer_load_dwordx4 v[88:91], v2, s[32:35], s95 offen offset:2048 nt
s_waitcnt vmcnt(4)
buffer_load_dwordx4 v[92:95], v2, s[32:35], s95 offen offset:2176 nt
s_waitcnt vmcnt(4)
buffer_load_dwordx4 v[96:99], v2, s[32:35], s95 offen offset:2560 nt
s_waitcnt vmcnt(4)
buffer_load_dwordx4 v[100:103], v2, s[32:35], s95 offen offset:2688 nt
L_lve_8:
s_mov_b64 exec, 1
s_cmp_eq_u32 s21, 0
s_cbranch_scc1 L_fl_15
s_mov_b32 s21, 0
s_waitcnt vmcnt(4)
v_add_u32 v21, 2, v21
ds_write_b32 v5, v21 offset:48
L_fl_15:
ds_add_rtn_u32 v20, v5, v6 offset:40
ds_read_b32 v0, v5 offset:48
ds_read_b32 v19, v5 offset:4
s_waitcnt lgkmcnt(0)
v_readfirstlane_b32 s93, v20
v_readfirstlane_b32 s92, v0
s_and_b32 s94, s93, 15
s_cmp_lg_u32 s94, 0
s_cbranch_scc1 L_nt_14
v_cmp_eq_u32 vcc, 0, v19
s_cbranch_vccnz L_nt_14
s_lshl_b32 s94, s93, 4
s_add_u32 s94, s94, s22
v_mov_b32 v21, 1
s_mov_b32 s21, 1
buffer_atomic_add v21, off, s[64:67], s94 sc0 sc1
L_nt_14:
s_mov_b64 exec, -1
s_cmp_ge_u32 s93, 22
s_cbranch_scc1 L_lv_12
s_cmp_gt_u32 s92, 20
s_cbranch_scc1 L_lv_12
s_sub_u32 s92, s92, 1
s_cmp_ge_u32 s92, 8
s_cbranch_scc1 L_lv_11
s_add_u32 s95, s86, 8388608
s_waitcnt vmcnt(1)
buffer_load_dwordx4 v[104:107], v2, s[32:35], s95 offen offset:0 nt
s_waitcnt vmcnt(1)
buffer_load_dwordx4 v[108:111], v2, s[32:35], s95 offen offset:128 nt
s_waitcnt vmcnt(1)
buffer_load_dwordx4 v[112:115], v2, s[32:35], s95 offen offset:512 nt
s_waitcnt vmcnt(1)
buffer_load_dwordx4 v[116:119], v2, s[32:35], s95 offen offset:640 nt
s_branch L_lve_13
L_lv_11:
s_add_u32 s95, s86, 8388608
s_waitcnt vmcnt(2)
buffer_load_dwordx4 v[104:107], v2, s[32:35], s95 offen offset:0 nt
s_waitcnt vmcnt(2)
buffer_load_dwordx4 v[108:111], v2, s[32:35], s95 offen offset:128 nt
s_waitcnt vmcnt(2)
buffer_load_dwordx4 v[112:115], v2, s[32:35], s95 offen offset:512 nt
s_waitcnt vmcnt(2)
buffer_load_dwordx4 v[116:119], v2, s[32:35], s95 offen offset:640 nt
s_branch L_lve_13
L_lv_12:
s_add_u32 s95, s86, 8388608
s_waitcnt vmcnt(4)
buffer_load_dwordx4 v[104:107], v2, s[32:35], s95 offen offset:0 nt
s_waitcnt vmcnt(4)
buffer_load_dwordx4 v[108:111], v2, s[32:35], s95 offen offset:128 nt
s_waitcnt vmcnt(4)
buffer_load_dwordx4 v[112:115], v2, s[32:35], s95 offen offset:512 nt
s_waitcnt vmcnt(4)
buffer_load_dwordx4 v[116:119], v2, s[32:35], s95 offen offset:640 nt
L_lve_13:
s_mov_b64 exec, 1
s_cmp_eq_u32 s21, 0
s_cbranch_scc1 L_fl_20
s_mov_b32 s21, 0
s_waitcnt vmcnt(4)
v_add_u32 v21, 2, v21
ds_write_b32 v5, v21 offset:48
L_fl_20:
ds_add_rtn_u32 v20, v5, v6 offset:40
ds_read_b32 v0, v5 offset:48
ds_read_b32 v19, v5 offset:4
s_waitcnt lgkmcnt(0)
v_readfirstlane_b32 s93, v20
v_readfirstlane_b32 s92, v0
s_and_b32 s94, s93, 15
s_cmp_lg_u32 s94, 0
s_cbranch_scc1 L_nt_19
v_cmp_eq_u32 vcc, 0, v19
s_cbranch_vccnz L_nt_19
s_lshl_b32 s94, s93, 4
s_add_u32 s94, s94, s22
v_mov_b32 v21, 1
s_mov_b32 s21, 1
buffer_atomic_add v21, off, s[64:67], s94 sc0 sc1
L_nt_19:
s_mov_b64 exec, -1
s_cmp_ge_u32 s93, 30
s_cbranch_scc1 L_lv_17
s_cmp_gt_u32 s92, 20
s_cbranch_scc1 L_lv_17
s_sub_u32 s92, s92, 1
s_cmp_ge_u32 s92, 8
s_cbranch_scc1 L_lv_16
s_add_u32 s95, s86, 8388608
s_waitcnt vmcnt(1)
buffer_load_dwordx4 v[120:123], v2, s[32:35], s95 offen offset:2048 nt
s_waitcnt vmcnt(1)
buffer_load_dwordx4 v[124:127], v2, s[32:35], s95 offen offset:2176 nt
s_waitcnt vmcnt(1)
buffer_load_dwordx4 v[128:131], v2, s[32:35], s95 offen offset:2560 nt
s_waitcnt vmcnt(1)
buffer_load_dwordx4 v[132:135], v2, s[32:35], s95 offen offset:2688 nt
s_branch L_lve_18
L_lv_16:
s_add_u32 s95, s86, 8388608
s_waitcnt vmcnt(2)
buffer_load_dwordx4 v[120:123], v2, s[32:35], s95 offen offset:2048 nt
s_waitcnt vmcnt(2)
buffer_load_dwordx4 v[124:127], v2, s[32:35], s95 offen offset:2176 nt
s_waitcnt vmcnt(2)
buffer_load_dwordx4 v[128:131], v2, s[32:35], s95 offen offset:2560 nt
s_waitcnt vmcnt(2)
buffer_load_dwordx4 v[132:135], v2, s[32:35], s95 offen offset:2688 nt
s_branch L_lve_18
L_lv_17:
s_add_u32 s95, s86, 8388608
s_waitcnt vmcnt(4)
buffer_load_dwordx4 v[120:123], v2, s[32:35], s95 offen offset:2048 nt
s_waitcnt vmcnt(4)
buffer_load_dwordx4 v[124:127], v2, s[32:35], s95 offen offset:2176 nt
s_waitcnt vmcnt(4)
buffer_load_dwordx4 v[128:131], v2, s[32:35], s95 offen offset:2560 nt
s_waitcnt vmcnt(4)
buffer_load_dwordx4 v[132:135], v2, s[32:35], s95 offen offset:2688 nt
L_lve_18:
s_mov_b64 exec, 1
s_cmp_eq_u32 s21, 0
s_cbranch_scc1 L_fl_25
s_mov_b32 s21, 0
s_waitcnt vmcnt(4)
v_add_u32 v21, 2, v21
ds_write_b32 v5, v21 offset:48
L_fl_25:
ds_add_rtn_u32 v20, v5, v6 offset:40
ds_read_b32 v0, v5 offset:48
ds_read_b32 v19, v5 offset:4
s_waitcnt lgkmcnt(0)
v_readfirstlane_b32 s93, v20
v_readfirstlane_b32 s92, v0
s_and_b32 s94, s93, 15
s_cmp_lg_u32 s94, 0
s_cbranch_scc1 L_nt_24
v_cmp_eq_u32 vcc, 0, v19
s_cbranch_vccnz L_nt_24
s_lshl_b32 s94, s93, 4
s_add_u32 s94, s94, s22
v_mov_b32 v21, 1
s_mov_b32 s21, 1
buffer_atomic_add v21, off, s[64:67], s94 sc0 sc1
L_nt_24:
s_mov_b64 exec, -1
s_cmp_ge_u32 s93, 38
s_cbranch_scc1 L_lv_22
s_cmp_gt_u32 s92, 20
s_cbranch_scc1 L_lv_22
s_sub_u32 s92, s92, 1
s_cmp_ge_u32 s92, 8
s_cbranch_scc1 L_lv_21
s_add_u32 s95, s86, 12582912
s_waitcnt vmcnt(1)
buffer_load_dwordx4 v[136:139], v2, s[32:35], s95 offen offset:0 nt
s_waitcnt vmcnt(1)
buffer_load_dwordx4 v[140:143], v2, s[32:35], s95 offen offset:128 nt
s_waitcnt vmcnt(1)
buffer_load_dwordx4 v[144:147], v2, s[32:35], s95 offen offset:512 nt
s_waitcnt vmcnt(1)
buffer_load_dwordx4 v[148:151], v2, s[32:35], s95 offen offset:640 nt
s_branch L_lve_23
L_lv_21:
s_add_u32 s95, s86, 12582912
s_waitcnt vmcnt(2)
buffer_load_dwordx4 v[136:139], v2, s[32:35], s95 offen offset:0 nt
s_waitcnt vmcnt(2)
buffer_load_dwordx4 v[140:143], v2, s[32:35], s95 offen offset:128 nt
s_waitcnt vmcnt(2)
buffer_load_dwordx4 v[144:147], v2, s[32:35], s95 offen offset:512 nt
s_waitcnt vmcnt(2)
buffer_load_dwordx4 v[148:151], v2, s[32:35], s95 offen offset:640 nt
s_branch L_lve_23
L_lv_22:
s_add_u32 s95, s86, 12582912
s_waitcnt vmcnt(4)
buffer_load_dwordx4 v[136:139], v2, s[32:35], s95 offen offset:0 nt
s_waitcnt vmcnt(4)
buffer_load_dwordx4 v[140:143], v2, s[32:35], s95 offen offset:128 nt
s_waitcnt vmcnt(4)
buffer_load_dwordx4 v[144:147], v2, s[32:35], s95 offen offset:512 nt
s_waitcnt vmcnt(4)
buffer_load_dwordx4 v[148:151], v2, s[32:35], s95 offen offset:640 nt
L_lve_23:
s_waitcnt lgkmcnt(0)
s_mov_b64 exec, 1
ds_add_u32 v5, v6 offset:24
s_mov_b64 exec, -1
s_mov_b64 exec, 1
s_cmp_eq_u32 s21, 0
s_cbranch_scc1 L_fl_30
s_mov_b32 s21, 0
s_waitcnt vmcnt(4)
v_add_u32 v21, 2, v21
ds_write_b32 v5, v21 offset:48
L_fl_30:
ds_add_rtn_u32 v20, v5, v6 offset:40
ds_read_b32 v0, v5 offset:48
ds_read_b32 v19, v5 offset:4
s_waitcnt lgkmcnt(0)
v_readfirstlane_b32 s93, v20
v_readfirstlane_b32 s92, v0
s_and_b32 s94, s93, 15
s_cmp_lg_u32 s94, 0
s_cbranch_scc1 L_nt_29
v_cmp_eq_u32 vcc, 0, v19
s_cbranch_vccnz L_nt_29
s_lshl_b32 s94, s93, 4
s_add_u32 s94, s94, s22
v_mov_b32 v21, 1
s_mov_b32 s21, 1
buffer_atomic_add v21, off, s[64:67], s94 sc0 sc1
L_nt_29:
s_mov_b64 exec, -1
s_cmp_ge_u32 s93, 46
s_cbranch_scc1 L_lv_27
s_cmp_gt_u32 s92, 20
s_cbranch_scc1 L_lv_27
s_sub_u32 s92, s92, 1
s_cmp_ge_u32 s92, 8
s_cbranch_scc1 L_lv_26
s_add_u32 s95, s86, 12582912
s_waitcnt vmcnt(1)
buffer_load_dwordx4 v[152:155], v2, s[32:35], s95 offen offset:2048 nt
s_waitcnt vmcnt(1)
buffer_load_dwordx4 v[156:159], v2, s[32:35], s95 offen offset:2176 nt
s_waitcnt vmcnt(1)
buffer_load_dwordx4 v[160:163], v2, s[32:35], s95 offen offset:2560 nt
s_waitcnt vmcnt(1)
buffer_load_dwordx4 v[164:167], v2, s[32:35], s95 offen offset:2688 nt
s_branch L_lve_28
L_lv_26:
s_add_u32 s95, s86, 12582912
s_waitcnt vmcnt(2)
buffer_load_dwordx4 v[152:155], v2, s[32:35], s95 offen offset:2048 nt
s_waitcnt vmcnt(2)
buffer_load_dwordx4 v[156:159], v2, s[32:35], s95 offen offset:2176 nt
s_waitcnt vmcnt(2)
buffer_load_dwordx4 v[160:163], v2, s[32:35], s95 offen offset:2560 nt
s_waitcnt vmcnt(2)
buffer_load_dwordx4 v[164:167], v2, s[32:35], s95 offen offset:2688 nt
s_branch L_lve_28
L_lv_27:
s_add_u32 s95, s86, 12582912
s_waitcnt vmcnt(4)
buffer_load_dwordx4 v[152:155], v2, s[32:35], s95 offen offset:2048 nt
s_waitcnt vmcnt(4)
buffer_load_dwordx4 v[156:159], v2, s[32:35], s95 offen offset:2176 nt
s_waitcnt vmcnt(4)
buffer_load_dwordx4 v[160:163], v2, s[32:35], s95 offen offset:2560 nt
s_waitcnt vmcnt(4)
buffer_load_dwordx4 v[164:167], v2, s[32:35], s95 offen offset:2688 nt
L_lve_28:
s_setprio 2
s_add_u32 m0, s4, 0
s_add_u32 s95, s86, 0
buffer_load_dwordx4 v3, s[36:39], s95 offen offset:0 nt lds
buffer_load_dwordx4 v4, s[36:39], s95 offen offset:1024 nt lds
buffer_load_dwordx4 v3, s[36:39], s95 offen offset:2048 nt lds
buffer_load_dwordx4 v4, s[36:39], s95 offen offset:3072 nt lds
s_add_u32 m0, s4, 4096
s_add_u32 s95, s86, 4096
buffer_load_dwordx4 v3, s[36:39], s95 offen offset:0 nt lds
buffer_load_dwordx4 v4, s[36:39], s95 offen offset:1024 nt lds
buffer_load_dwordx4 v3, s[36:39], s95 offen offset:2048 nt lds
buffer_load_dwordx4 v4, s[36:39], s95 offen offset:3072 nt lds
s_mov_b64 exec, 1
s_cmp_eq_u32 s21, 0
s_cbranch_scc1 L_fl_31
s_mov_b32 s21, 0
s_waitcnt vmcnt(12)
v_add_u32 v21, 2, v21
ds_write_b32 v5, v21 offset:48
L_fl_31:
s_mov_b64 exec, -1
s_lshl_b32 s101, s3, 6
s_mul_i32 s50, s2, 2304
s_add_u32 s50, s50, 180224
s_lshl_b32 s48, s3, 8
s_add_u32 s48, s48, s50
s_lshr_b32 s92, s85, 3
s_lshl_b32 s92, s92, 3
s_add_u32 s90, s92, s87
s_lshl_b32 s92, s90, 14
s_add_u32 s100, s92, 966656
s_lshl_b32 s12, s87, 7
s_add_u32 s12, s12, 1556480
s_lshl_b32 s92, s87, 3
s_mov_b32 s96, 437389826
s_mov_b32 s97, 271723042
s_cmp_ge_u32 s90, 8
s_cselect_b32 s96, 471075844, s96
s_cselect_b32 s97, 3419172, s97
s_lshr_b64 s[96:97], s[96:97], s92
s_and_b32 s7, s96, 0xff
s_lshl_b32 s7, s7, 7
s_mov_b32 s96, 555751704
s_mov_b32 s97, 825239848
s_cmp_ge_u32 s90, 8
s_cselect_b32 s96, 504761862, s96
s_cselect_b32 s97, 137768486, s97
s_lshr_b64 s[96:97], s[96:97], s92
s_and_b32 s13, s96, 0xff
s_lshl_b32 s13, s13, 7
s_mov_b32 s16, 0x55555555
s_mov_b32 s17, 0x55555555
s_cmp_lg_u32 s89, 0
s_cbranch_scc1 L_base_x
s_lshl_b32 s92, s88, 7
s_lshl_b32 s93, s3, 4
s_add_u32 s92, s92, s93
s_lshl_b32 s9, s92, 1
s_mul_i32 s6, s92, 7168
s_lshl_b32 s93, s88, 11
s_add_u32 s11, s100, s93
s_lshl_b32 s93, s3, 9
s_add_u32 s11, s11, s93
s_add_u32 s49, s11, 262144
s_lshl_b32 s92, s88, 13
s_lshl_b32 s93, s3, 10
s_add_u32 s92, s92, s93
s_add_u32 s10, s92, 835584
s_lshl_b32 s92, s90, 11
s_add_u32 s19, s92, 901120
s_add_u32 s20, s19, 32768
s_lshl_b32 s92, s88, 8
s_lshl_b32 s93, s3, 5
s_add_u32 s92, s92, s93
s_add_u32 s8, s92, s19
s_mov_b32 s5, 7168
s_cmp_lt_u32 s90, 8
s_cselect_b32 s51, 67108864, 0
s_branch L_base_j
L_base_x:
s_lshr_b32 s92, s85, 2
s_lshl_b32 s93, s87, 8
s_lshl_b32 s94, s3, 5
s_add_u32 s94, s94, s92
s_mul_i32 s94, s94, 2304
s_add_u32 s93, s93, s94
s_add_u32 s10, s93, 180224
s_lshl_b32 s92, s92, 3
s_add_u32 s92, s92, s87
s_and_b32 s94, s85, 3
s_lshl_b32 s93, s92, 8
s_lshl_b32 s11, s94, 14
s_add_u32 s11, s11, s93
s_lshl_b32 s93, s3, 13
s_add_u32 s11, s11, s93
s_add_u32 s11, s11, 835584
s_lshl_b32 s92, s92, 18
s_lshl_b32 s93, s3, 15
s_add_u32 s92, s92, s93
s_lshl_b32 s94, s94, 9
s_add_u32 s6, s92, s94
s_cmp_lt_u32 s3, 4
s_cselect_b32 s92, s7, s13
s_lshl_b32 s92, s92, 10
s_and_b32 s93, s3, 3
s_lshl_b32 s93, s93, 16
s_mov_b32 s7, 0
s_mov_b32 s13, 256
s_add_u32 s92, s92, s93
s_lshl_b32 s93, s88, 8
s_add_u32 s8, s92, s93
s_lshl_b32 s92, s88, 12
s_lshl_b32 s93, s90, 8
s_add_u32 s92, s92, s93
s_add_u32 s49, s92, 1490944
s_lshl_b32 s92, s3, 7
s_add_u32 s19, s92, s100
s_add_u32 s20, s19, 262144
s_mov_b32 s51, 0
s_mov_b32 s9, 0
s_mov_b32 s5, 2048
L_base_j:
v_and_b32 v24, 7, v1
v_mul_u32_u24 v24, 272, v24
v_lshl_add_u32 v24, v32, 4, v24
v_add_u32 v24, 135168, v24
v_bfe_u32 v26, v1, 3, 1
v_lshl_add_u32 v25, v26, 6, v24
s_mov_b32 s91, 0
L_lw_32:
ds_read_b32 v0, v5 offset:12
s_waitcnt lgkmcnt(0)
v_cmp_gt_u32 vcc, 4, v0
s_cbranch_vccz L_lwok_33
s_add_u32 s91, s91, 1
s_cmp_gt_u32 s91, 960000
s_cbranch_scc1 L_end
s_sleep 2
s_branch L_lw_32
L_lwok_33:
ds_read_b128 v[8:11], v25 offset:0
ds_read_b128 v[12:15], v25 offset:128
s_waitcnt lgkmcnt(0)
s_waitcnt vmcnt(32)
v_mfma_f32_16x16x32_bf16 v[24:27], v[40:43], v[8:11], 0
v_mfma_f32_16x16x32_bf16 v[28:31], v[48:51], v[8:11], 0
v_mfma_f32_16x16x32_bf16 v[32:35], v[56:59], v[8:11], 0
v_mfma_f32_16x16x32_bf16 v[36:39], v[64:67], v[8:11], 0
v_mfma_f32_16x16x32_bf16 v[24:27], v[44:47], v[12:15], v[24:27]
v_mfma_f32_16x16x32_bf16 v[28:31], v[52:55], v[12:15], v[28:31]
v_mfma_f32_16x16x32_bf16 v[32:35], v[60:63], v[12:15], v[32:35]
v_mfma_f32_16x16x32_bf16 v[36:39], v[68:71], v[12:15], v[36:39]
s_waitcnt vmcnt(24)
v_mfma_f32_16x16x32_bf16 v[40:43], v[72:75], v[8:11], 0
v_mfma_f32_16x16x32_bf16 v[44:47], v[80:83], v[8:11], 0
v_mfma_f32_16x16x32_bf16 v[48:51], v[88:91], v[8:11], 0
v_mfma_f32_16x16x32_bf16 v[52:55], v[96:99], v[8:11], 0
v_mfma_f32_16x16x32_bf16 v[40:43], v[76:79], v[12:15], v[40:43]
v_mfma_f32_16x16x32_bf16 v[44:47], v[84:87], v[12:15], v[44:47]
v_mfma_f32_16x16x32_bf16 v[48:51], v[92:95], v[12:15], v[48:51]
v_mfma_f32_16x16x32_bf16 v[52:55], v[100:103], v[12:15], v[52:55]
v_add_f32_dpp v56, v25, v24 row_ror:8 row_mask:0xf bank_mask:0x3
v_add_f32_dpp v57, v27, v26 row_ror:8 row_mask:0xf bank_mask:0x3
v_add_f32_dpp v58, v29, v28 row_ror:8 row_mask:0xf bank_mask:0x3
v_add_f32_dpp v59, v31, v30 row_ror:8 row_mask:0xf bank_mask:0x3
v_add_f32_dpp v56, v32, v33 row_ror:8 row_mask:0xf bank_mask:0xc
v_add_f32_dpp v57, v34, v35 row_ror:8 row_mask:0xf bank_mask:0xc
v_add_f32_dpp v58, v36, v37 row_ror:8 row_mask:0xf bank_mask:0xc
v_add_f32_dpp v59, v38, v39 row_ror:8 row_mask:0xf bank_mask:0xc
v_cvt_pk_bf16_f32 v57, v56, v57
v_lshlrev_b32 v56, 16, v57
v_and_b32 v57, 0xffff0000, v57
v_mul_f32 v56, 1035273459, v56
v_mul_f32 v57, 1035273459, v57
v_cvt_pk_bf16_f32 v57, v56, v57
v_lshlrev_b32 v56, 16, v57
v_and_b32 v57, 0xffff0000, v57
v_cvt_pk_bf16_f32 v59, v58, v59
v_lshlrev_b32 v58, 16, v59
v_and_b32 v59, 0xffff0000, v59
v_mul_f32 v58, 1035273459, v58
v_mul_f32 v59, 1035273459, v59
v_cvt_pk_bf16_f32 v59, v58, v59
v_lshlrev_b32 v58, 16, v59
v_and_b32 v59, 0xffff0000, v59
s_waitcnt vmcnt(16)
v_mfma_f32_16x16x32_bf16 v[24:27], v[104:107], v[8:11], 0
v_mfma_f32_16x16x32_bf16 v[28:31], v[112:115], v[8:11], 0
v_mfma_f32_16x16x32_bf16 v[32:35], v[120:123], v[8:11], 0
v_mfma_f32_16x16x32_bf16 v[36:39], v[128:131], v[8:11], 0
v_mfma_f32_16x16x32_bf16 v[24:27], v[108:111], v[12:15], v[24:27]
v_mfma_f32_16x16x32_bf16 v[28:31], v[116:119], v[12:15], v[28:31]
v_mfma_f32_16x16x32_bf16 v[32:35], v[124:127], v[12:15], v[32:35]
v_mfma_f32_16x16x32_bf16 v[36:39], v[132:135], v[12:15], v[36:39]
v_add_f32_dpp v60, v41, v40 row_ror:8 row_mask:0xf bank_mask:0x3
v_add_f32_dpp v61, v43, v42 row_ror:8 row_mask:0xf bank_mask:0x3
v_add_f32_dpp v62, v45, v44 row_ror:8 row_mask:0xf bank_mask:0x3
v_add_f32_dpp v63, v47, v46 row_ror:8 row_mask:0xf bank_mask:0x3
v_add_f32_dpp v60, v48, v49 row_ror:8 row_mask:0xf bank_mask:0xc
v_add_f32_dpp v61, v50, v51 row_ror:8 row_mask:0xf bank_mask:0xc
v_add_f32_dpp v62, v52, v53 row_ror:8 row_mask:0xf bank_mask:0xc
v_add_f32_dpp v63, v54, v55 row_ror:8 row_mask:0xf bank_mask:0xc
v_cvt_pk_bf16_f32 v61, v60, v61
v_lshlrev_b32 v60, 16, v61
v_and_b32 v61, 0xffff0000, v61
v_mul_f32 v60, 1035273459, v60
v_mul_f32 v61, 1035273459, v61
v_cvt_pk_bf16_f32 v61, v60, v61
v_lshlrev_b32 v60, 16, v61
v_and_b32 v61, 0xffff0000, v61
v_cvt_pk_bf16_f32 v63, v62, v63
v_lshlrev_b32 v62, 16, v63
v_and_b32 v63, 0xffff0000, v63
v_mul_f32 v62, 1035273459, v62
v_mul_f32 v63, 1035273459, v63
v_cvt_pk_bf16_f32 v63, v62, v63
v_lshlrev_b32 v62, 16, v63
v_and_b32 v63, 0xffff0000, v63
s_waitcnt vmcnt(8)
v_mfma_f32_16x16x32_bf16 v[40:43], v[136:139], v[8:11], 0
v_mfma_f32_16x16x32_bf16 v[44:47], v[144:147], v[8:11], 0
v_mfma_f32_16x16x32_bf16 v[48:51], v[152:155], v[8:11], 0
v_mfma_f32_16x16x32_bf16 v[52:55], v[160:163], v[8:11], 0
v_mfma_f32_16x16x32_bf16 v[40:43], v[140:143], v[12:15], v[40:43]
v_mfma_f32_16x16x32_bf16 v[44:47], v[148:151], v[12:15], v[44:47]
v_mfma_f32_16x16x32_bf16 v[48:51], v[156:159], v[12:15], v[48:51]
v_mfma_f32_16x16x32_bf16 v[52:55], v[164:167], v[12:15], v[52:55]
v_add_f32_dpp v64, v25, v24 row_ror:8 row_mask:0xf bank_mask:0x3
v_add_f32_dpp v65, v27, v26 row_ror:8 row_mask:0xf bank_mask:0x3
v_add_f32_dpp v66, v29, v28 row_ror:8 row_mask:0xf bank_mask:0x3
v_add_f32_dpp v67, v31, v30 row_ror:8 row_mask:0xf bank_mask:0x3
v_add_f32_dpp v64, v32, v33 row_ror:8 row_mask:0xf bank_mask:0xc
v_add_f32_dpp v65, v34, v35 row_ror:8 row_mask:0xf bank_mask:0xc
v_add_f32_dpp v66, v36, v37 row_ror:8 row_mask:0xf bank_mask:0xc
v_add_f32_dpp v67, v38, v39 row_ror:8 row_mask:0xf bank_mask:0xc
v_cvt_pk_bf16_f32 v65, v64, v65
v_lshlrev_b32 v64, 16, v65
v_and_b32 v65, 0xffff0000, v65
v_mul_f32 v64, 1035273459, v64
v_mul_f32 v65, 1035273459, v65
v_cvt_pk_bf16_f32 v65, v64, v65
v_lshlrev_b32 v64, 16, v65
v_and_b32 v65, 0xffff0000, v65
v_cvt_pk_bf16_f32 v67, v66, v67
v_lshlrev_b32 v66, 16, v67
v_and_b32 v67, 0xffff0000, v67
v_mul_f32 v66, 1035273459, v66
v_mul_f32 v67, 1035273459, v67
v_cvt_pk_bf16_f32 v67, v66, v67
v_lshlrev_b32 v66, 16, v67
v_and_b32 v67, 0xffff0000, v67
v_add_f32_dpp v68, v41, v40 row_ror:8 row_mask:0xf bank_mask:0x3
v_add_f32_dpp v69, v43, v42 row_ror:8 row_mask:0xf bank_mask:0x3
v_add_f32_dpp v70, v45, v44 row_ror:8 row_mask:0xf bank_mask:0x3
v_add_f32_dpp v71, v47, v46 row_ror:8 row_mask:0xf bank_mask:0x3
v_add_f32_dpp v68, v48, v49 row_ror:8 row_mask:0xf bank_mask:0xc
v_add_f32_dpp v69, v50, v51 row_ror:8 row_mask:0xf bank_mask:0xc
v_add_f32_dpp v70, v52, v53 row_ror:8 row_mask:0xf bank_mask:0xc
v_add_f32_dpp v71, v54, v55 row_ror:8 row_mask:0xf bank_mask:0xc
v_cvt_pk_bf16_f32 v69, v68, v69
v_lshlrev_b32 v68, 16, v69
v_and_b32 v69, 0xffff0000, v69
v_mul_f32 v68, 1035273459, v68
v_mul_f32 v69, 1035273459, v69
v_cvt_pk_bf16_f32 v69, v68, v69
v_lshlrev_b32 v68, 16, v69
v_and_b32 v69, 0xffff0000, v69
v_cvt_pk_bf16_f32 v71, v70, v71
v_lshlrev_b32 v70, 16, v71
v_and_b32 v71, 0xffff0000, v71
v_mul_f32 v70, 1035273459, v70
v_mul_f32 v71, 1035273459, v71
v_cvt_pk_bf16_f32 v71, v70, v71
v_lshlrev_b32 v70, 16, v71
v_and_b32 v71, 0xffff0000, v71
v_max3_f32 v88, v56, v57, v58
v_max3_f32 v88, v88, v59, v60
v_max3_f32 v88, v88, v61, v62
v_max3_f32 v88, v88, v63, v64
v_max3_f32 v88, v88, v65, v66
v_max3_f32 v88, v88, v67, v68
v_max3_f32 v88, v88, v69, v70
v_max_f32 v88, v88, v71
s_nop 1
v_max_f32_dpp v88, v88, v88 row_ror:8 row_mask:0xf bank_mask:0xf
v_mov_b32 v89, v88
s_nop 1
v_permlane16_swap_b32 v89, v88
v_max_f32 v88, v88, v89
v_mov_b32 v89, v88
s_nop 1
v_permlane32_swap_b32 v89, v88
v_max_f32 v88, v88, v89
v_sub_f32 v56, v56, v88
v_sub_f32 v57, v57, v88
v_sub_f32 v58, v58, v88
v_sub_f32 v59, v59, v88
v_sub_f32 v60, v60, v88
v_sub_f32 v61, v61, v88
v_sub_f32 v62, v62, v88
v_sub_f32 v63, v63, v88
v_sub_f32 v64, v64, v88
v_sub_f32 v65, v65, v88
v_sub_f32 v66, v66, v88
v_sub_f32 v67, v67, v88
v_sub_f32 v68, v68, v88
v_sub_f32 v69, v69, v88
v_sub_f32 v70, v70, v88
v_sub_f32 v71, v71, v88
v_mul_f32 v56, 1069066811, v56
v_mul_f32 v57, 1069066811, v57
v_mul_f32 v58, 1069066811, v58
v_mul_f32 v59, 1069066811, v59
v_mul_f32 v60, 1069066811, v60
v_mul_f32 v61, 1069066811, v61
v_mul_f32 v62, 1069066811, v62
v_mul_f32 v63, 1069066811, v63
v_mul_f32 v64, 1069066811, v64
v_mul_f32 v65, 1069066811, v65
v_mul_f32 v66, 1069066811, v66
v_mul_f32 v67, 1069066811, v67
v_mul_f32 v68, 1069066811, v68
v_mul_f32 v69, 1069066811, v69
v_mul_f32 v70, 1069066811, v70
v_mul_f32 v71, 1069066811, v71
v_exp_f32 v56, v56
v_exp_f32 v57, v57
v_exp_f32 v58, v58
v_exp_f32 v59, v59
v_exp_f32 v60, v60
v_exp_f32 v61, v61
v_exp_f32 v62, v62
v_exp_f32 v63, v63
v_exp_f32 v64, v64
v_exp_f32 v65, v65
v_exp_f32 v66, v66
v_exp_f32 v67, v67
v_exp_f32 v68, v68
v_exp_f32 v69, v69
v_exp_f32 v70, v70
v_exp_f32 v71, v71
v_add_f32 v89, v56, v57
v_add_f32 v89, v89, v58
v_add_f32 v89, v89, v59
v_add_f32 v89, v89, v60
v_add_f32 v89, v89, v61
v_add_f32 v89, v89, v62
v_add_f32 v89, v89, v63
v_add_f32 v89, v89, v64
v_add_f32 v89, v89, v65
v_add_f32 v89, v89, v66
v_add_f32 v89, v89, v67
v_add_f32 v89, v89, v68
v_add_f32 v89, v89, v69
v_add_f32 v89, v89, v70
v_add_f32 v89, v89, v71
s_nop 1
v_add_f32_dpp v89, v89, v89 row_ror:8 row_mask:0xf bank_mask:0xf
v_mov_b32 v90, v89
s_nop 1
v_permlane16_swap_b32 v90, v89
v_add_f32 v89, v89, v90
v_mov_b32 v90, v89
s_nop 1
v_permlane32_swap_b32 v90, v89
v_add_f32 v89, v89, v90
v_lshlrev_b32 v25, 3, v1
s_add_u32 s92, s101, 137472
v_add_u32 v90, s92, v25
s_mov_b64 exec, 0xff
ds_write_b64 v90, v[88:89]
s_waitcnt lgkmcnt(0)
s_mov_b64 exec, 1
ds_add_rtn_u32 v91, v5, v6 offset:16
s_mov_b64 exec, -1
v_cvt_pk_bf16_f32 v40, v56, v57
v_cvt_pk_bf16_f32 v41, v58, v59
v_cvt_pk_bf16_f32 v42, v60, v61
v_cvt_pk_bf16_f32 v43, v62, v63
v_cvt_pk_bf16_f32 v44, v64, v65
v_cvt_pk_bf16_f32 v45, v66, v67
v_cvt_pk_bf16_f32 v46, v68, v69
v_cvt_pk_bf16_f32 v47, v70, v71
v_lshrrev_b32 v48, 4, v1
v_and_b32 v49, 15, v1
v_and_b32 v50, 3, v1
v_lshrrev_b32 v51, 2, v49
v_and_b32 v53, 1, v48
v_lshl_add_u32 v52, v53, 2, v51
v_lshrrev_b32 v53, 1, v48
v_lshl_add_u32 v53, v53, 4, v52
v_lshlrev_b32 v53, 8, v53
v_lshl_add_u32 v53, v50, 3, v53
v_add_u32 v53, s4, v53
v_xor_b32 v54, 0, v52
v_lshl_add_u32 v12, v54, 5, v53
v_xor_b32 v54, 1, v52
v_lshl_add_u32 v13, v54, 5, v53
v_xor_b32 v54, 2, v52
v_lshl_add_u32 v14, v54, 5, v53
v_xor_b32 v54, 3, v52
v_lshl_add_u32 v15, v54, 5, v53
v_xor_b32 v54, 4, v52
v_lshl_add_u32 v16, v54, 5, v53
v_xor_b32 v54, 5, v52
v_lshl_add_u32 v17, v54, 5, v53
v_xor_b32 v54, 6, v52
v_lshl_add_u32 v18, v54, 5, v53
v_xor_b32 v54, 7, v52
v_lshl_add_u32 v19, v54, 5, v53
v_lshlrev_b32 v54, 4, v49
v_and_b32 v53, 1, v48
v_lshrrev_b32 v52, 1, v48
v_lshl_add_u32 v53, v53, 2, v52
v_lshl_add_u32 v24, v53, 11, v54
v_mad_u32_u24 v22, v53, s5, v54
v_and_b32 v53, 8, v1
v_mul_lo_u32 v53, v53, s51
v_add3_u32 v2, v22, s13, v53
v_add_u32 v22, s7, v22
v_lshl_add_u32 v27, v50, 2, v48
v_lshlrev_b32 v27, 1, v27
s_waitcnt lgkmcnt(0)
v_readfirstlane_b32 s92, v91
s_cmp_lg_u32 s92, 7
s_cbranch_scc1 L_notlast
v_add_u32 v90, 137472, v25
ds_read_b64 v[92:93], v90
v_lshrrev_b32 v96, 3, v1
v_and_b32 v97, 7, v1
v_lshlrev_b32 v97, 5, v97
v_lshl_add_u32 v96, v96, 2, v97
v_add_u32 v96, 137984, v96
s_waitcnt lgkmcnt(0)
v_mov_b32 v94, v92
s_nop 1
v_max_f32_dpp v94, v94, v94 row_ror:8 row_mask:0xf bank_mask:0xf
v_mov_b32 v95, v94
s_nop 1
v_permlane16_swap_b32 v95, v94
v_max_f32 v94, v94, v95
v_mov_b32 v95, v94
s_nop 1
v_permlane32_swap_b32 v95, v94
v_max_f32 v94, v94, v95
v_sub_f32 v92, v92, v94
v_mul_f32 v92, 1069066811, v92
v_exp_f32 v92, v92
s_nop 0
v_mul_f32 v95, v93, v92
ds_write_b32 v96, v92
s_nop 0
v_add_f32_dpp v95, v95, v95 row_ror:8 row_mask:0xf bank_mask:0xf
v_mov_b32 v93, v95
s_nop 1
v_permlane16_swap_b32 v93, v95
v_add_f32 v95, v95, v93
v_mov_b32 v93, v95
s_nop 1
v_permlane32_swap_b32 v93, v95
v_add_f32 v95, v95, v93
v_min_u32 v94, -2, v94
v_min_u32 v95, -2, v95
s_add_u32 s92, s50, 2048
s_mov_b64 exec, 0xff
s_setprio 3
buffer_store_dwordx2 v[94:95], v25, s[64:67], s92 offen sc1
s_mov_b64 exec, -1
s_waitcnt lgkmcnt(0)
L_notlast:
v_mov_b32 v72, 0
v_mov_b32 v73, 0
v_mov_b32 v74, 0
v_mov_b32 v75, 0
v_mov_b32 v76, 0
v_mov_b32 v77, 0
v_mov_b32 v78, 0
v_mov_b32 v79, 0
v_mov_b32 v80, 0
v_mov_b32 v81, 0
v_mov_b32 v82, 0
v_mov_b32 v83, 0
v_mov_b32 v84, 0
v_mov_b32 v85, 0
v_mov_b32 v86, 0
v_mov_b32 v87, 0
v_mov_b32 v88, 0
v_mov_b32 v89, 0
v_mov_b32 v90, 0
v_mov_b32 v91, 0
v_mov_b32 v92, 0
v_mov_b32 v93, 0
v_mov_b32 v94, 0
v_mov_b32 v95, 0
v_mov_b32 v96, 0
v_mov_b32 v97, 0
v_mov_b32 v98, 0
v_mov_b32 v99, 0
v_mov_b32 v100, 0
v_mov_b32 v101, 0
v_mov_b32 v102, 0
v_mov_b32 v103, 0
v_mov_b32_dpp v72, v40 quad_perm:[0,1,2,3] row_mask:0xf bank_mask:0x3
v_mov_b32_dpp v74, v40 row_ror:8 row_mask:0xf bank_mask:0x3
v_mov_b32_dpp v76, v40 row_ror:8 row_mask:0xf bank_mask:0xc
v_mov_b32_dpp v78, v40 quad_perm:[0,1,2,3] row_mask:0xf bank_mask:0xc
v_mov_b32_dpp v73, v41 quad_perm:[0,1,2,3] row_mask:0xf bank_mask:0x3
v_mov_b32_dpp v75, v41 row_ror:8 row_mask:0xf bank_mask:0x3
v_mov_b32_dpp v77, v41 row_ror:8 row_mask:0xf bank_mask:0xc
v_mov_b32_dpp v79, v41 quad_perm:[0,1,2,3] row_mask:0xf bank_mask:0xc
v_mov_b32_dpp v80, v42 quad_perm:[0,1,2,3] row_mask:0xf bank_mask:0x3
v_mov_b32_dpp v82, v42 row_ror:8 row_mask:0xf bank_mask:0x3
v_mov_b32_dpp v84, v42 row_ror:8 row_mask:0xf bank_mask:0xc
v_mov_b32_dpp v86, v42 quad_perm:[0,1,2,3] row_mask:0xf bank_mask:0xc
v_mov_b32_dpp v81, v43 quad_perm:[0,1,2,3] row_mask:0xf bank_mask:0x3
v_mov_b32_dpp v83, v43 row_ror:8 row_mask:0xf bank_mask:0x3
v_mov_b32_dpp v85, v43 row_ror:8 row_mask:0xf bank_mask:0xc
v_mov_b32_dpp v87, v43 quad_perm:[0,1,2,3] row_mask:0xf bank_mask:0xc
v_mov_b32_dpp v88, v44 quad_perm:[0,1,2,3] row_mask:0xf bank_mask:0x3
v_mov_b32_dpp v90, v44 row_ror:8 row_mask:0xf bank_mask:0x3
v_mov_b32_dpp v92, v44 row_ror:8 row_mask:0xf bank_mask:0xc
v_mov_b32_dpp v94, v44 quad_perm:[0,1,2,3] row_mask:0xf bank_mask:0xc
v_mov_b32_dpp v89, v45 quad_perm:[0,1,2,3] row_mask:0xf bank_mask:0x3
v_mov_b32_dpp v91, v45 row_ror:8 row_mask:0xf bank_mask:0x3
v_mov_b32_dpp v93, v45 row_ror:8 row_mask:0xf bank_mask:0xc
v_mov_b32_dpp v95, v45 quad_perm:[0,1,2,3] row_mask:0xf bank_mask:0xc
v_mov_b32_dpp v96, v46 quad_perm:[0,1,2,3] row_mask:0xf bank_mask:0x3
v_mov_b32_dpp v98, v46 row_ror:8 row_mask:0xf bank_mask:0x3
v_mov_b32_dpp v100, v46 row_ror:8 row_mask:0xf bank_mask:0xc
v_mov_b32_dpp v102, v46 quad_perm:[0,1,2,3] row_mask:0xf bank_mask:0xc
v_mov_b32_dpp v97, v47 quad_perm:[0,1,2,3] row_mask:0xf bank_mask:0x3
v_mov_b32_dpp v99, v47 row_ror:8 row_mask:0xf bank_mask:0x3
v_mov_b32_dpp v101, v47 row_ror:8 row_mask:0xf bank_mask:0xc
v_mov_b32_dpp v103, v47 quad_perm:[0,1,2,3] row_mask:0xf bank_mask:0xc
s_setprio 1
s_and_b32 s92, s90, 8
s_add_u32 s92, s92, 6
s_cmp_ge_u32 s3, s92
s_cselect_b32 s92, 536870912, 0
v_or_b32 v24, s92, v24
s_mov_b64 exec, 1
s_cmp_eq_u32 s21, 0
s_cbranch_scc1 L_fl_38
s_mov_b32 s21, 0
s_waitcnt vmcnt(4)
v_add_u32 v21, 2, v21
ds_write_b32 v5, v21 offset:48
L_fl_38:
ds_add_rtn_u32 v20, v5, v6 offset:40
ds_read_b32 v0, v5 offset:48
s_waitcnt lgkmcnt(0)
v_readfirstlane_b32 s93, v20
v_readfirstlane_b32 s92, v0
s_and_b32 s94, s93, 15
s_cmp_lg_u32 s94, 0
s_cbranch_scc1 L_nt_37
s_lshl_b32 s94, s93, 4
s_add_u32 s94, s94, s22
v_mov_b32 v21, 1
s_mov_b32 s21, 1
buffer_atomic_add v21, off, s[64:67], s94 sc0 sc1
L_nt_37:
s_mov_b64 exec, -1
s_cmp_ge_u32 s93, 54
s_cbranch_scc1 L_lv_35
s_cmp_gt_u32 s92, 20
s_cbranch_scc1 L_lv_35
s_sub_u32 s92, s92, 1
s_cmp_ge_u32 s92, 8
s_cbranch_scc1 L_lv_34
s_add_u32 m0, s4, 8192
s_add_u32 s95, s86, 4194304
s_waitcnt vmcnt(1)
buffer_load_dwordx4 v3, s[36:39], s95 offen offset:0 nt lds
s_waitcnt vmcnt(1)
buffer_load_dwordx4 v4, s[36:39], s95 offen offset:1024 nt lds
s_waitcnt vmcnt(1)
buffer_load_dwordx4 v3, s[36:39], s95 offen offset:2048 nt lds
s_waitcnt vmcnt(1)
buffer_load_dwordx4 v4, s[36:39], s95 offen offset:3072 nt lds
s_branch L_lve_36
L_lv_34:
s_add_u32 m0, s4, 8192
s_add_u32 s95, s86, 4194304
s_waitcnt vmcnt(2)
buffer_load_dwordx4 v3, s[36:39], s95 offen offset:0 nt lds
s_waitcnt vmcnt(2)
buffer_load_dwordx4 v4, s[36:39], s95 offen offset:1024 nt lds
s_waitcnt vmcnt(2)
buffer_load_dwordx4 v3, s[36:39], s95 offen offset:2048 nt lds
s_waitcnt vmcnt(2)
buffer_load_dwordx4 v4, s[36:39], s95 offen offset:3072 nt lds
s_branch L_lve_36
L_lv_35:
s_add_u32 m0, s4, 8192
s_add_u32 s95, s86, 4194304
s_waitcnt vmcnt(4)
buffer_load_dwordx4 v3, s[36:39], s95 offen offset:0 nt lds
s_waitcnt vmcnt(4)
buffer_load_dwordx4 v4, s[36:39], s95 offen offset:1024 nt lds
s_waitcnt vmcnt(4)
buffer_load_dwordx4 v3, s[36:39], s95 offen offset:2048 nt lds
s_waitcnt vmcnt(4)
buffer_load_dwordx4 v4, s[36:39], s95 offen offset:3072 nt lds
L_lve_36:
s_mov_b64 exec, 1
s_cmp_eq_u32 s21, 0
s_cbranch_scc1 L_fl_43
s_mov_b32 s21, 0
s_waitcnt vmcnt(4)
v_add_u32 v21, 2, v21
ds_write_b32 v5, v21 offset:48
L_fl_43:
ds_add_rtn_u32 v20, v5, v6 offset:40
ds_read_b32 v0, v5 offset:48
s_waitcnt lgkmcnt(0)
v_readfirstlane_b32 s93, v20
v_readfirstlane_b32 s92, v0
s_and_b32 s94, s93, 15
s_cmp_lg_u32 s94, 0
s_cbranch_scc1 L_nt_42
s_lshl_b32 s94, s93, 4
s_add_u32 s94, s94, s22
v_mov_b32 v21, 1
s_mov_b32 s21, 1
buffer_atomic_add v21, off, s[64:67], s94 sc0 sc1
L_nt_42:
s_mov_b64 exec, -1
s_cmp_ge_u32 s93, 62
s_cbranch_scc1 L_lv_40
s_cmp_gt_u32 s92, 20
s_cbranch_scc1 L_lv_40
s_sub_u32 s92, s92, 1
s_cmp_ge_u32 s92, 8
s_cbranch_scc1 L_lv_39
s_add_u32 m0, s4, 12288
s_add_u32 s95, s86, 4198400
s_waitcnt vmcnt(1)
buffer_load_dwordx4 v3, s[36:39], s95 offen offset:0 nt lds
s_waitcnt vmcnt(1)
buffer_load_dwordx4 v4, s[36:39], s95 offen offset:1024 nt lds
s_waitcnt vmcnt(1)
buffer_load_dwordx4 v3, s[36:39], s95 offen offset:2048 nt lds
s_waitcnt vmcnt(1)
buffer_load_dwordx4 v4, s[36:39], s95 offen offset:3072 nt lds
s_branch L_lve_41
L_lv_39:
s_add_u32 m0, s4, 12288
s_add_u32 s95, s86, 4198400
s_waitcnt vmcnt(2)
buffer_load_dwordx4 v3, s[36:39], s95 offen offset:0 nt lds
s_waitcnt vmcnt(2)
buffer_load_dwordx4 v4, s[36:39], s95 offen offset:1024 nt lds
s_waitcnt vmcnt(2)
buffer_load_dwordx4 v3, s[36:39], s95 offen offset:2048 nt lds
s_waitcnt vmcnt(2)
buffer_load_dwordx4 v4, s[36:39], s95 offen offset:3072 nt lds
s_branch L_lve_41
L_lv_40:
s_add_u32 m0, s4, 12288
s_add_u32 s95, s86, 4198400
s_waitcnt vmcnt(4)
buffer_load_dwordx4 v3, s[36:39], s95 offen offset:0 nt lds
s_waitcnt vmcnt(4)
buffer_load_dwordx4 v4, s[36:39], s95 offen offset:1024 nt lds
s_waitcnt vmcnt(4)
buffer_load_dwordx4 v3, s[36:39], s95 offen offset:2048 nt lds
s_waitcnt vmcnt(4)
buffer_load_dwordx4 v4, s[36:39], s95 offen offset:3072 nt lds
L_lve_41:
s_waitcnt vmcnt(8)
ds_read_b64_tr_b16 v[120:121], v12 offset:0
ds_read_b64_tr_b16 v[122:123], v12 offset:2048
ds_read_b64_tr_b16 v[124:125], v13 offset:0
ds_read_b64_tr_b16 v[126:127], v13 offset:2048
ds_read_b64_tr_b16 v[128:129], v14 offset:0
ds_read_b64_tr_b16 v[130:131], v14 offset:2048
ds_read_b64_tr_b16 v[132:133], v15 offset:0
ds_read_b64_tr_b16 v[134:135], v15 offset:2048
s_waitcnt lgkmcnt(6)
v_mfma_f32_16x16x32_bf16 v[104:107], v[120:123], v[72:75], 0
ds_read_b64_tr_b16 v[120:121], v16 offset:0
ds_read_b64_tr_b16 v[122:123], v16 offset:2048
s_waitcnt lgkmcnt(6)
v_mfma_f32_16x16x32_bf16 v[108:111], v[124:127], v[72:75], 0
ds_read_b64_tr_b16 v[124:125], v17 offset:0
ds_read_b64_tr_b16 v[126:127], v17 offset:2048
s_waitcnt lgkmcnt(6)
v_mfma_f32_16x16x32_bf16 v[112:115], v[128:131], v[72:75], 0
ds_read_b64_tr_b16 v[128:129], v18 offset:0
ds_read_b64_tr_b16 v[130:131], v18 offset:2048
s_waitcnt lgkmcnt(6)
v_mfma_f32_16x16x32_bf16 v[116:119], v[132:135], v[72:75], 0
ds_read_b64_tr_b16 v[132:133], v19 offset:0
ds_read_b64_tr_b16 v[134:135], v19 offset:2048
s_waitcnt lgkmcnt(6)
v_mfma_f32_16x16x32_bf16 v[104:107], v[120:123], v[76:79], v[104:107]
s_waitcnt lgkmcnt(4)
v_mfma_f32_16x16x32_bf16 v[108:111], v[124:127], v[76:79], v[108:111]
s_waitcnt lgkmcnt(2)
v_mfma_f32_16x16x32_bf16 v[112:115], v[128:131], v[76:79], v[112:115]
s_waitcnt lgkmcnt(0)
v_mfma_f32_16x16x32_bf16 v[116:119], v[132:135], v[76:79], v[116:119]
buffer_load_ushort v28, v27, s[68:71], s9 offen
s_mov_b64 exec, 1
s_cmp_eq_u32 s21, 0
s_cbranch_scc1 L_fl_48
s_mov_b32 s21, 0
s_waitcnt vmcnt(4)
v_add_u32 v21, 2, v21
ds_write_b32 v5, v21 offset:48
L_fl_48:
ds_add_rtn_u32 v20, v5, v6 offset:40
ds_read_b32 v0, v5 offset:48
s_waitcnt lgkmcnt(0)
v_readfirstlane_b32 s93, v20
v_readfirstlane_b32 s92, v0
s_and_b32 s94, s93, 15
s_cmp_lg_u32 s94, 0
s_cbranch_scc1 L_nt_47
s_lshl_b32 s94, s93, 4
s_add_u32 s94, s94, s22
v_mov_b32 v21, 1
s_mov_b32 s21, 1
buffer_atomic_add v21, off, s[64:67], s94 sc0 sc1
L_nt_47:
s_mov_b64 exec, -1
s_cmp_ge_u32 s93, 70
s_cbranch_scc1 L_lv_45
s_cmp_gt_u32 s92, 20
s_cbranch_scc1 L_lv_45
s_sub_u32 s92, s92, 1
s_cmp_ge_u32 s92, 8
s_cbranch_scc1 L_lv_44
s_mov_b32 s95, s6
s_waitcnt vmcnt(1)
buffer_load_dwordx4 v[40:43], v22, s[44:47], s95 offen nt
s_waitcnt vmcnt(1)
buffer_load_dwordx4 v[56:59], v2, s[44:47], s95 offen nt
s_mul_i32 s95, s5, 2
s_add_u32 s95, s95, s6
s_waitcnt vmcnt(1)
buffer_load_dwordx4 v[44:47], v22, s[44:47], s95 offen nt
s_waitcnt vmcnt(1)
buffer_load_dwordx4 v[60:63], v2, s[44:47], s95 offen nt
s_branch L_lve_46
L_lv_44:
s_mov_b32 s95, s6
s_waitcnt vmcnt(2)
buffer_load_dwordx4 v[40:43], v22, s[44:47], s95 offen nt
s_waitcnt vmcnt(2)
buffer_load_dwordx4 v[56:59], v2, s[44:47], s95 offen nt
s_mul_i32 s95, s5, 2
s_add_u32 s95, s95, s6
s_waitcnt vmcnt(2)
buffer_load_dwordx4 v[44:47], v22, s[44:47], s95 offen nt
s_waitcnt vmcnt(2)
buffer_load_dwordx4 v[60:63], v2, s[44:47], s95 offen nt
s_branch L_lve_46
L_lv_45:
s_mov_b32 s95, s6
s_waitcnt vmcnt(4)
buffer_load_dwordx4 v[40:43], v22, s[44:47], s95 offen nt
s_waitcnt vmcnt(4)
buffer_load_dwordx4 v[56:59], v2, s[44:47], s95 offen nt
s_mul_i32 s95, s5, 2
s_add_u32 s95, s95, s6
s_waitcnt vmcnt(4)
buffer_load_dwordx4 v[44:47], v22, s[44:47], s95 offen nt
s_waitcnt vmcnt(4)
buffer_load_dwordx4 v[60:63], v2, s[44:47], s95 offen nt
L_lve_46:
s_and_b32 s51, s2, 216
s_cmp_eq_u32 s51, 200
s_cselect_b32 s51, 1, 0
s_cbranch_scc0 L_ds
s_add_u32 s95, s8, 0
s_waitcnt vmcnt(3)
buffer_load_dwordx4 v[136:139], v24, s[56:59], s95 offen nt
s_add_u32 s95, s8, 4096
s_waitcnt vmcnt(3)
buffer_load_dwordx4 v[140:143], v24, s[56:59], s95 offen nt
L_ds:
s_mov_b64 exec, 1
s_cmp_eq_u32 s21, 0
s_cbranch_scc1 L_fl_53
s_mov_b32 s21, 0
s_waitcnt vmcnt(4)
v_add_u32 v21, 2, v21
ds_write_b32 v5, v21 offset:48
L_fl_53:
ds_add_rtn_u32 v20, v5, v6 offset:40
ds_read_b32 v0, v5 offset:48
s_waitcnt lgkmcnt(0)
v_readfirstlane_b32 s93, v20
v_readfirstlane_b32 s92, v0
s_and_b32 s94, s93, 15
s_cmp_lg_u32 s94, 0
s_cbranch_scc1 L_nt_52
s_lshl_b32 s94, s93, 4
s_add_u32 s94, s94, s22
v_mov_b32 v21, 1
s_mov_b32 s21, 1
buffer_atomic_add v21, off, s[64:67], s94 sc0 sc1
L_nt_52:
s_mov_b64 exec, -1
s_cmp_ge_u32 s93, 78
s_cbranch_scc1 L_lv_50
s_cmp_gt_u32 s92, 20
s_cbranch_scc1 L_lv_50
s_sub_u32 s92, s92, 1
s_cmp_ge_u32 s92, 8
s_cbranch_scc1 L_lv_49
s_add_u32 m0, s4, 0
s_add_u32 s95, s86, 8388608
s_waitcnt vmcnt(1)
buffer_load_dwordx4 v3, s[36:39], s95 offen offset:0 nt lds
s_waitcnt vmcnt(1)
buffer_load_dwordx4 v4, s[36:39], s95 offen offset:1024 nt lds
s_waitcnt vmcnt(1)
buffer_load_dwordx4 v3, s[36:39], s95 offen offset:2048 nt lds
s_waitcnt vmcnt(1)
buffer_load_dwordx4 v4, s[36:39], s95 offen offset:3072 nt lds
s_branch L_lve_51
L_lv_49:
s_add_u32 m0, s4, 0
s_add_u32 s95, s86, 8388608
s_waitcnt vmcnt(2)
buffer_load_dwordx4 v3, s[36:39], s95 offen offset:0 nt lds
s_waitcnt vmcnt(2)
buffer_load_dwordx4 v4, s[36:39], s95 offen offset:1024 nt lds
s_waitcnt vmcnt(2)
buffer_load_dwordx4 v3, s[36:39], s95 offen offset:2048 nt lds
s_waitcnt vmcnt(2)
buffer_load_dwordx4 v4, s[36:39], s95 offen offset:3072 nt lds
s_branch L_lve_51
L_lv_50:
s_add_u32 m0, s4, 0
s_add_u32 s95, s86, 8388608
s_waitcnt vmcnt(4)
buffer_load_dwordx4 v3, s[36:39], s95 offen offset:0 nt lds
s_waitcnt vmcnt(4)
buffer_load_dwordx4 v4, s[36:39], s95 offen offset:1024 nt lds
s_waitcnt vmcnt(4)
buffer_load_dwordx4 v3, s[36:39], s95 offen offset:2048 nt lds
s_waitcnt vmcnt(4)
buffer_load_dwordx4 v4, s[36:39], s95 offen offset:3072 nt lds
L_lve_51:
s_mov_b64 exec, 1
s_cmp_eq_u32 s21, 0
s_cbranch_scc1 L_fl_58
s_mov_b32 s21, 0
s_waitcnt vmcnt(4)
v_add_u32 v21, 2, v21
ds_write_b32 v5, v21 offset:48
L_fl_58:
ds_add_rtn_u32 v20, v5, v6 offset:40
ds_read_b32 v0, v5 offset:48
s_waitcnt lgkmcnt(0)
v_readfirstlane_b32 s93, v20
v_readfirstlane_b32 s92, v0
s_and_b32 s94, s93, 15
s_cmp_lg_u32 s94, 0
s_cbranch_scc1 L_nt_57
s_lshl_b32 s94, s93, 4
s_add_u32 s94, s94, s22
v_mov_b32 v21, 1
s_mov_b32 s21, 1
buffer_atomic_add v21, off, s[64:67], s94 sc0 sc1
L_nt_57:
s_mov_b64 exec, -1
s_cmp_ge_u32 s93, 86
s_cbranch_scc1 L_lv_55
s_cmp_gt_u32 s92, 20
s_cbranch_scc1 L_lv_55
s_sub_u32 s92, s92, 1
s_cmp_ge_u32 s92, 8
s_cbranch_scc1 L_lv_54
s_add_u32 m0, s4, 4096
s_add_u32 s95, s86, 8392704
s_waitcnt vmcnt(1)
buffer_load_dwordx4 v3, s[36:39], s95 offen offset:0 nt lds
s_waitcnt vmcnt(1)
buffer_load_dwordx4 v4, s[36:39], s95 offen offset:1024 nt lds
s_waitcnt vmcnt(1)
buffer_load_dwordx4 v3, s[36:39], s95 offen offset:2048 nt lds
s_waitcnt vmcnt(1)
buffer_load_dwordx4 v4, s[36:39], s95 offen offset:3072 nt lds
s_branch L_lve_56
L_lv_54:
s_add_u32 m0, s4, 4096
s_add_u32 s95, s86, 8392704
s_waitcnt vmcnt(2)
buffer_load_dwordx4 v3, s[36:39], s95 offen offset:0 nt lds
s_waitcnt vmcnt(2)
buffer_load_dwordx4 v4, s[36:39], s95 offen offset:1024 nt lds
s_waitcnt vmcnt(2)
buffer_load_dwordx4 v3, s[36:39], s95 offen offset:2048 nt lds
s_waitcnt vmcnt(2)
buffer_load_dwordx4 v4, s[36:39], s95 offen offset:3072 nt lds
s_branch L_lve_56
L_lv_55:
s_add_u32 m0, s4, 4096
s_add_u32 s95, s86, 8392704
s_waitcnt vmcnt(4)
buffer_load_dwordx4 v3, s[36:39], s95 offen offset:0 nt lds
s_waitcnt vmcnt(4)
buffer_load_dwordx4 v4, s[36:39], s95 offen offset:1024 nt lds
s_waitcnt vmcnt(4)
buffer_load_dwordx4 v3, s[36:39], s95 offen offset:2048 nt lds
s_waitcnt vmcnt(4)
buffer_load_dwordx4 v4, s[36:39], s95 offen offset:3072 nt lds
L_lve_56:
s_waitcnt vmcnt(13)
ds_read_b64_tr_b16 v[120:121], v12 offset:8192
ds_read_b64_tr_b16 v[122:123], v12 offset:10240
ds_read_b64_tr_b16 v[124:125], v13 offset:8192
ds_read_b64_tr_b16 v[126:127], v13 offset:10240
ds_read_b64_tr_b16 v[128:129], v14 offset:8192
ds_read_b64_tr_b16 v[130:131], v14 offset:10240
ds_read_b64_tr_b16 v[132:133], v15 offset:8192
ds_read_b64_tr_b16 v[134:135], v15 offset:10240
s_waitcnt lgkmcnt(6)
v_mfma_f32_16x16x32_bf16 v[104:107], v[120:123], v[80:83], v[104:107]
ds_read_b64_tr_b16 v[120:121], v16 offset:8192
ds_read_b64_tr_b16 v[122:123], v16 offset:10240
s_waitcnt lgkmcnt(6)
v_mfma_f32_16x16x32_bf16 v[108:111], v[124:127], v[80:83], v[108:111]
ds_read_b64_tr_b16 v[124:125], v17 offset:8192
ds_read_b64_tr_b16 v[126:127], v17 offset:10240
s_waitcnt lgkmcnt(6)
v_mfma_f32_16x16x32_bf16 v[112:115], v[128:131], v[80:83], v[112:115]
ds_read_b64_tr_b16 v[128:129], v18 offset:8192
ds_read_b64_tr_b16 v[130:131], v18 offset:10240
s_waitcnt lgkmcnt(6)
v_mfma_f32_16x16x32_bf16 v[116:119], v[132:135], v[80:83], v[116:119]
ds_read_b64_tr_b16 v[132:133], v19 offset:8192
ds_read_b64_tr_b16 v[134:135], v19 offset:10240
s_waitcnt lgkmcnt(6)
v_mfma_f32_16x16x32_bf16 v[104:107], v[120:123], v[84:87], v[104:107]
s_waitcnt lgkmcnt(4)
v_mfma_f32_16x16x32_bf16 v[108:111], v[124:127], v[84:87], v[108:111]
s_waitcnt lgkmcnt(2)
v_mfma_f32_16x16x32_bf16 v[112:115], v[128:131], v[84:87], v[112:115]
s_waitcnt lgkmcnt(0)
v_mfma_f32_16x16x32_bf16 v[116:119], v[132:135], v[84:87], v[116:119]
s_mov_b64 exec, 1
s_cmp_eq_u32 s21, 0
s_cbranch_scc1 L_fl_63
s_mov_b32 s21, 0
s_waitcnt vmcnt(4)
v_add_u32 v21, 2, v21
ds_write_b32 v5, v21 offset:48
L_fl_63:
ds_add_rtn_u32 v20, v5, v6 offset:40
ds_read_b32 v0, v5 offset:48
s_waitcnt lgkmcnt(0)
v_readfirstlane_b32 s93, v20
v_readfirstlane_b32 s92, v0
s_and_b32 s94, s93, 15
s_cmp_lg_u32 s94, 0
s_cbranch_scc1 L_nt_62
s_lshl_b32 s94, s93, 4
s_add_u32 s94, s94, s22
v_mov_b32 v21, 1
s_mov_b32 s21, 1
buffer_atomic_add v21, off, s[64:67], s94 sc0 sc1
L_nt_62:
s_mov_b64 exec, -1
s_cmp_ge_u32 s93, 94
s_cbranch_scc1 L_lv_60
s_cmp_gt_u32 s92, 20
s_cbranch_scc1 L_lv_60
s_sub_u32 s92, s92, 1
s_cmp_ge_u32 s92, 8
s_cbranch_scc1 L_lv_59
s_add_u32 m0, s4, 8192
s_add_u32 s95, s86, 12582912
s_waitcnt vmcnt(1)
buffer_load_dwordx4 v3, s[36:39], s95 offen offset:0 nt lds
s_waitcnt vmcnt(1)
buffer_load_dwordx4 v4, s[36:39], s95 offen offset:1024 nt lds
s_waitcnt vmcnt(1)
buffer_load_dwordx4 v3, s[36:39], s95 offen offset:2048 nt lds
s_waitcnt vmcnt(1)
buffer_load_dwordx4 v4, s[36:39], s95 offen offset:3072 nt lds
s_branch L_lve_61
L_lv_59:
s_add_u32 m0, s4, 8192
s_add_u32 s95, s86, 12582912
s_waitcnt vmcnt(2)
buffer_load_dwordx4 v3, s[36:39], s95 offen offset:0 nt lds
s_waitcnt vmcnt(2)
buffer_load_dwordx4 v4, s[36:39], s95 offen offset:1024 nt lds
s_waitcnt vmcnt(2)
buffer_load_dwordx4 v3, s[36:39], s95 offen offset:2048 nt lds
s_waitcnt vmcnt(2)
buffer_load_dwordx4 v4, s[36:39], s95 offen offset:3072 nt lds
s_branch L_lve_61
L_lv_60:
s_add_u32 m0, s4, 8192
s_add_u32 s95, s86, 12582912
s_waitcnt vmcnt(4)
buffer_load_dwordx4 v3, s[36:39], s95 offen offset:0 nt lds
s_waitcnt vmcnt(4)
buffer_load_dwordx4 v4, s[36:39], s95 offen offset:1024 nt lds
s_waitcnt vmcnt(4)
buffer_load_dwordx4 v3, s[36:39], s95 offen offset:2048 nt lds
s_waitcnt vmcnt(4)
buffer_load_dwordx4 v4, s[36:39], s95 offen offset:3072 nt lds
L_lve_61:
s_mov_b64 exec, 1
s_cmp_eq_u32 s21, 0
s_cbranch_scc1 L_fl_68
s_mov_b32 s21, 0
s_waitcnt vmcnt(4)
v_add_u32 v21, 2, v21
ds_write_b32 v5, v21 offset:48
L_fl_68:
ds_add_rtn_u32 v20, v5, v6 offset:40
ds_read_b32 v0, v5 offset:48
s_waitcnt lgkmcnt(0)
v_readfirstlane_b32 s93, v20
v_readfirstlane_b32 s92, v0
s_mov_b64 exec, -1
s_cmp_ge_u32 s93, 102
s_cbranch_scc1 L_lv_65
s_cmp_gt_u32 s92, 20
s_cbranch_scc1 L_lv_65
s_sub_u32 s92, s92, 1
s_cmp_ge_u32 s92, 8
s_cbranch_scc1 L_lv_64
s_add_u32 m0, s4, 12288
s_add_u32 s95, s86, 12587008
s_waitcnt vmcnt(1)
buffer_load_dwordx4 v3, s[36:39], s95 offen offset:0 nt lds
s_waitcnt vmcnt(1)
buffer_load_dwordx4 v4, s[36:39], s95 offen offset:1024 nt lds
s_waitcnt vmcnt(1)
buffer_load_dwordx4 v3, s[36:39], s95 offen offset:2048 nt lds
s_waitcnt vmcnt(1)
buffer_load_dwordx4 v4, s[36:39], s95 offen offset:3072 nt lds
s_branch L_lve_66
L_lv_64:
s_add_u32 m0, s4, 12288
s_add_u32 s95, s86, 12587008
s_waitcnt vmcnt(2)
buffer_load_dwordx4 v3, s[36:39], s95 offen offset:0 nt lds
s_waitcnt vmcnt(2)
buffer_load_dwordx4 v4, s[36:39], s95 offen offset:1024 nt lds
s_waitcnt vmcnt(2)
buffer_load_dwordx4 v3, s[36:39], s95 offen offset:2048 nt lds
s_waitcnt vmcnt(2)
buffer_load_dwordx4 v4, s[36:39], s95 offen offset:3072 nt lds
s_branch L_lve_66
.p2alignl 12, 0xbf810000
L_pad1619:
s_branch L_warm_done
L_lv_65:
s_add_u32 m0, s4, 12288
s_add_u32 s95, s86, 12587008
s_waitcnt vmcnt(4)
buffer_load_dwordx4 v3, s[36:39], s95 offen offset:0 nt lds
s_waitcnt vmcnt(4)
buffer_load_dwordx4 v4, s[36:39], s95 offen offset:1024 nt lds
s_waitcnt vmcnt(4)
buffer_load_dwordx4 v3, s[36:39], s95 offen offset:2048 nt lds
s_waitcnt vmcnt(4)
buffer_load_dwordx4 v4, s[36:39], s95 offen offset:3072 nt lds
L_lve_66:
s_waitcnt lgkmcnt(0)
s_mov_b64 exec, 1
ds_add_u32 v5, v6 offset:28
s_mov_b64 exec, -1
s_setprio 0
s_setprio 3
s_waitcnt vmcnt(8)
ds_read_b64_tr_b16 v[120:121], v12 offset:0
ds_read_b64_tr_b16 v[122:123], v12 offset:2048
ds_read_b64_tr_b16 v[124:125], v13 offset:0
ds_read_b64_tr_b16 v[126:127], v13 offset:2048
ds_read_b64_tr_b16 v[128:129], v14 offset:0
ds_read_b64_tr_b16 v[130:131], v14 offset:2048
ds_read_b64_tr_b16 v[132:133], v15 offset:0
ds_read_b64_tr_b16 v[134:135], v15 offset:2048
s_waitcnt lgkmcnt(6)
v_mfma_f32_16x16x32_bf16 v[104:107], v[120:123], v[88:91], v[104:107]
ds_read_b64_tr_b16 v[120:121], v16 offset:0
ds_read_b64_tr_b16 v[122:123], v16 offset:2048
s_waitcnt lgkmcnt(6)
v_mfma_f32_16x16x32_bf16 v[108:111], v[124:127], v[88:91], v[108:111]
ds_read_b64_tr_b16 v[124:125], v17 offset:0
ds_read_b64_tr_b16 v[126:127], v17 offset:2048
s_waitcnt lgkmcnt(6)
v_mfma_f32_16x16x32_bf16 v[112:115], v[128:131], v[88:91], v[112:115]
ds_read_b64_tr_b16 v[128:129], v18 offset:0
ds_read_b64_tr_b16 v[130:131], v18 offset:2048
s_waitcnt lgkmcnt(6)
v_mfma_f32_16x16x32_bf16 v[116:119], v[132:135], v[88:91], v[116:119]
ds_read_b64_tr_b16 v[132:133], v19 offset:0
ds_read_b64_tr_b16 v[134:135], v19 offset:2048
s_waitcnt lgkmcnt(6)
v_mfma_f32_16x16x32_bf16 v[104:107], v[120:123], v[92:95], v[104:107]
s_waitcnt lgkmcnt(4)
v_mfma_f32_16x16x32_bf16 v[108:111], v[124:127], v[92:95], v[108:111]
s_waitcnt lgkmcnt(2)
v_mfma_f32_16x16x32_bf16 v[112:115], v[128:131], v[92:95], v[112:115]
s_waitcnt lgkmcnt(0)
v_mfma_f32_16x16x32_bf16 v[116:119], v[132:135], v[92:95], v[116:119]
v_lshrrev_b32 v84, 4, v1
v_and_b32 v85, 15, v1
v_and_b32 v86, 3, v1
v_mul_u32_u24 v4, 0x5555, v86
v_mov_b32 v35, -2
v_lshlrev_b32 v26, 5, v85
v_and_b32 v86, 1, v84
v_lshl_add_u32 v26, v86, 4, v26
v_lshrrev_b32 v86, 1, v84
v_lshl_add_u32 v26, v86, 9, v26
s_lshl_b32 s92, s3, 10
v_add_u32 v26, s92, v26
v_and_b32 v86, 7, v1
v_mul_u32_u24 v72, 528, v86
v_lshl_add_u32 v72, v84, 4, v72
v_lshrrev_b32 v86, 3, v85
v_lshl_add_u32 v72, v86, 8, v72
v_add_u32 v72, s4, v72
s_mul_i32 s92, s3, 528
v_add_u32 v73, s92, v25
v_add_u32 v74, 65536, v73
s_lshl_b32 s92, s3, 5
s_add_u32 s92, s92, 137984
v_mov_b32 v75, s92
v_and_b32 v86, 3, v1
v_lshlrev_b32 v86, 4, v86
v_lshrrev_b32 v87, 2, v1
v_lshl_add_u32 v21, v87, 9, v86
s_cmp_lg_u32 s89, 0
s_mov_b32 s92, 256
s_cselect_b32 s92, 9216, s92
v_lshlrev_b32 v86, 4, v85
v_mad_u32_u24 v20, v84, s92, v86
s_lshl_b32 s92, s3, 5
s_add_u32 s92, s92, 138496
v_lshl_add_u32 v77, v84, 3, s92
v_lshlrev_b32 v23, 2, v1
v_and_b32 v86, 7, v1
v_lshlrev_b32 v86, 4, v86
v_lshrrev_b32 v87, 3, v1
v_lshl_add_u32 v34, v87, 11, v86
v_lshlrev_b32 v28, 16, v28
s_add_u32 s92, s101, 139520
v_lshl_add_u32 v76, v27, 1, s92
s_and_b32 s92, s3, 1
s_lshl_b32 s92, s92, 9
s_bfe_u32 s93, s3, 0x10001
s_lshl_b32 s93, s93, 14
s_add_u32 s92, s92, s93
s_add_u32 s92, s92, 8192
v_add_u32 v3, s92, v25
s_waitcnt vmcnt(0)
ds_read_b64_tr_b16 v[120:121], v12 offset:8192
ds_read_b64_tr_b16 v[122:123], v12 offset:10240
ds_read_b64_tr_b16 v[124:125], v13 offset:8192
ds_read_b64_tr_b16 v[126:127], v13 offset:10240
ds_read_b64_tr_b16 v[128:129], v14 offset:8192
ds_read_b64_tr_b16 v[130:131], v14 offset:10240
ds_read_b64_tr_b16 v[132:133], v15 offset:8192
ds_read_b64_tr_b16 v[134:135], v15 offset:10240
s_waitcnt lgkmcnt(6)
v_mfma_f32_16x16x32_bf16 v[104:107], v[120:123], v[96:99], v[104:107]
ds_read_b64_tr_b16 v[120:121], v16 offset:8192
ds_read_b64_tr_b16 v[122:123], v16 offset:10240
s_waitcnt lgkmcnt(6)
v_mfma_f32_16x16x32_bf16 v[108:111], v[124:127], v[96:99], v[108:111]
ds_read_b64_tr_b16 v[124:125], v17 offset:8192
ds_read_b64_tr_b16 v[126:127], v17 offset:10240
s_waitcnt lgkmcnt(6)
v_mfma_f32_16x16x32_bf16 v[112:115], v[128:131], v[96:99], v[112:115]
ds_read_b64_tr_b16 v[128:129], v18 offset:8192
ds_read_b64_tr_b16 v[130:131], v18 offset:10240
s_waitcnt lgkmcnt(6)
v_mfma_f32_16x16x32_bf16 v[116:119], v[132:135], v[96:99], v[116:119]
ds_read_b64_tr_b16 v[132:133], v19 offset:8192
ds_read_b64_tr_b16 v[134:135], v19 offset:10240
s_waitcnt lgkmcnt(6)
v_mfma_f32_16x16x32_bf16 v[104:107], v[120:123], v[100:103], v[104:107]
s_waitcnt lgkmcnt(4)
v_mfma_f32_16x16x32_bf16 v[108:111], v[124:127], v[100:103], v[108:111]
s_waitcnt lgkmcnt(2)
v_mfma_f32_16x16x32_bf16 v[112:115], v[128:131], v[100:103], v[112:115]
s_waitcnt lgkmcnt(0)
v_mfma_f32_16x16x32_bf16 v[116:119], v[132:135], v[100:103], v[116:119]
s_nop 1
ds_write_b128 v72, v[104:107] offset:0
s_nop 0
ds_write_b128 v72, v[108:111] offset:64
s_nop 0
ds_write_b128 v72, v[112:115] offset:128
s_nop 0
ds_write_b128 v72, v[116:119] offset:192
s_mov_b32 s91, 0
L_lw_69:
ds_read_b32 v0, v5 offset:28
s_waitcnt lgkmcnt(0)
v_cmp_gt_u32 vcc, 8, v0
s_cbranch_vccz L_lwok_70
s_add_u32 s91, s91, 1
s_cmp_gt_u32 s91, 960000
s_cbranch_scc1 L_end
s_sleep 2
s_branch L_lw_69
L_lwok_70:
s_cmp_lg_u32 s89, 0
s_cbranch_scc1 L_prex
s_mul_i32 s95, s5, 8
s_add_u32 s95, s95, s6
buffer_load_dwordx4 v[48:51], v22, s[44:47], s95 offen nt
buffer_load_dwordx4 v[64:67], v2, s[44:47], s95 offen nt
s_mul_i32 s95, s5, 10
s_add_u32 s95, s95, s6
buffer_load_dwordx4 v[52:55], v22, s[44:47], s95 offen nt
buffer_load_dwordx4 v[68:71], v2, s[44:47], s95 offen nt
s_branch L_prej
L_pad1785:
s_branch L_pad1619
L_prex:
s_mul_i32 s95, s5, 8
s_add_u32 s95, s95, s6
buffer_load_dwordx4 v[48:51], v22, s[44:47], s95 offen nt
buffer_load_dwordx4 v[64:67], v2, s[44:47], s95 offen nt
s_mul_i32 s95, s5, 10
s_add_u32 s95, s95, s6
buffer_load_dwordx4 v[52:55], v22, s[44:47], s95 offen nt
buffer_load_dwordx4 v[68:71], v2, s[44:47], s95 offen nt
L_prej:
s_waitcnt lgkmcnt(0)
s_barrier
ds_read_b128 v[120:123], v75
ds_read_b64 v[88:89], v73 offset:0
ds_read_b64 v[90:91], v73 offset:16384
ds_read_b64 v[92:93], v73 offset:32768
ds_read_b64 v[94:95], v73 offset:49152
ds_read_b128 v[124:127], v75 offset:16
ds_read_b64 v[96:97], v74 offset:0
ds_read_b64 v[98:99], v74 offset:16384
ds_read_b64 v[100:101], v74 offset:32768
ds_read_b64 v[102:103], v74 offset:49152
s_waitcnt lgkmcnt(5)
v_pk_mul_f32 v[80:81], v[88:89], v[120:121] op_sel:[0,0] op_sel_hi:[1,0]
v_pk_mul_f32 v[82:83], v[90:91], v[120:121] op_sel:[0,1] op_sel_hi:[1,1]
v_pk_fma_f32 v[80:81], v[92:93], v[122:123], v[80:81] op_sel:[0,0,0] op_sel_hi:[1,0,1]
v_pk_fma_f32 v[82:83], v[94:95], v[122:123], v[82:83] op_sel:[0,1,0] op_sel_hi:[1,1,1]
s_waitcnt lgkmcnt(0)
v_pk_fma_f32 v[80:81], v[96:97], v[124:125], v[80:81] op_sel:[0,0,0] op_sel_hi:[1,0,1]
v_pk_fma_f32 v[82:83], v[98:99], v[124:125], v[82:83] op_sel:[0,1,0] op_sel_hi:[1,1,1]
v_pk_fma_f32 v[80:81], v[100:101], v[126:127], v[80:81] op_sel:[0,0,0] op_sel_hi:[1,0,1]
v_pk_fma_f32 v[82:83], v[102:103], v[126:127], v[82:83] op_sel:[0,1,0] op_sel_hi:[1,1,1]
v_pk_add_f32 v[80:81], v[80:81], v[82:83]
v_cvt_pk_bf16_f32 v80, v80, v81
v_min_u32 v80, -2, v80
buffer_store_dword v80, v23, s[64:67], s48 offen sc1
s_setprio 0
s_mul_i32 s92, s3, -480
s_add_u32 s92, s92, 106496
v_add_u32 v16, s92, v26
v_bfe_u32 v17, v1, 2, 2
v_mul_u32_u24 v17, 1088, v17
v_add_u32 v17, v17, v76
v_subrev_u32 v17, 33024, v17
s_cmp_eq_u32 s89, 0
s_cbranch_scc1 L_tail_y
s_add_u32 s93, s10, 36864
s_lshl2_add_u32 s12, s85, s12
v_lshlrev_b32 v18, 10, v1
v_add_u32 v18, 8192, v18
buffer_load_dwordx4 v[88:91], v20, s[64:67], s10 offen sc1
buffer_load_dwordx4 v[92:95], v20, s[64:67], s93 offen sc1
v_mov_b64 v[96:97], 0
v_mov_b64 v[98:99], 0
v_mov_b64 v[100:101], 0
v_mov_b64 v[102:103], 0
v_mov_b64 v[104:105], 0
v_mov_b64 v[106:107], 0
v_mov_b64 v[108:109], 0
v_mov_b64 v[110:111], 0
v_mov_b64 v[112:113], 0
v_mov_b64 v[114:115], 0
v_mov_b64 v[116:117], 0
v_mov_b64 v[118:119], 0
v_mov_b64 v[120:121], 0
v_mov_b64 v[122:123], 0
v_mov_b64 v[124:125], 0
v_mov_b64 v[126:127], 0
v_mov_b64 v[128:129], 0
v_mov_b64 v[130:131], 0
v_mov_b64 v[132:133], 0
v_mov_b64 v[134:135], 0
v_mov_b64 v[8:9], 0
v_mov_b64 v[10:11], 0
v_mov_b64 v[36:37], 0
v_mov_b64 v[38:39], 0
s_mov_b32 s91, 0
L_lw_71:
ds_read_b32 v0, v5 offset:32
s_waitcnt lgkmcnt(0)
v_cmp_gt_u32 vcc, 1, v0
s_cbranch_vccz L_lwok_72
s_add_u32 s91, s91, 1
s_cmp_gt_u32 s91, 960000
s_cbranch_scc1 L_end
s_sleep 1
s_branch L_lw_71
L_lwok_72:
ds_read_b64 v[12:13], v77
s_waitcnt lgkmcnt(0)
v_mov_b32_dpp v100, v12 quad_perm:[0,1,2,3] row_mask:0xf bank_mask:0x1
v_mov_b32_dpp v101, v12 quad_perm:[0,1,2,3] row_mask:0xf bank_mask:0x2
v_mov_b32_dpp v102, v13 quad_perm:[0,1,2,3] row_mask:0xf bank_mask:0x1
v_mov_b32_dpp v103, v13 quad_perm:[0,1,2,3] row_mask:0xf bank_mask:0x2
s_waitcnt vmcnt(0)
s_mov_b32 s91, 0
L_retry_73:
v_smfmac_f32_16x16x64_bf16 v[96:99], v[100:103], v[88:95], v4
v_max3_u32 v0, v88, v89, v90
v_max3_u32 v0, v0, v91, v92
v_max3_u32 v0, v0, v93, v94
v_max_u32 v0, v0, v95
v_cmp_eq_u32 vcc, -1, v0
s_cbranch_vccz L_ok_74
s_add_u32 s91, s91, 1
s_cmp_gt_u32 s91, 60000
s_cbranch_scc1 L_end
s_sleep 2
s_mov_b64 exec, vcc
buffer_load_dwordx4 v[88:91], v20, s[64:67], s10 offen sc1
buffer_load_dwordx4 v[92:95], v20, s[64:67], s93 offen sc1
s_mov_b64 exec, -1
v_mov_b64 v[96:97], 0
v_mov_b64 v[98:99], 0
s_nop 1
s_waitcnt vmcnt(0)
s_branch L_retry_73
L_pad1902:
s_branch L_pad1785
L_ok_74:
s_mov_b32 exec_hi, 0
s_nop 0
ds_write_b128 v16, v[96:99]
s_mov_b64 exec, -1
s_waitcnt lgkmcnt(0)
s_barrier
ds_read2_b32 v[96:97], v17 offset0:0 offset1:136
s_waitcnt lgkmcnt(0)
v_add_f32 v76, v96, v97
s_nop 1
v_add_f32_dpp v76, v76, v76 row_ror:8 row_mask:0xf bank_mask:0xf
s_nop 1
v_add_f32_dpp v76, v76, v76 row_ror:4 row_mask:0xf bank_mask:0xf
v_cvt_pk_bf16_f32 v76, v76, 0
s_nop 1
v_mov_b32_dpp v104, v76 quad_perm:[0,0,0,0] row_mask:0xf bank_mask:0x1
v_mov_b32_dpp v105, v76 quad_perm:[0,0,0,0] row_mask:0xf bank_mask:0x2
v_mov_b32_dpp v106, v76 quad_perm:[1,1,1,1] row_mask:0xf bank_mask:0x1
v_mov_b32_dpp v107, v76 quad_perm:[1,1,1,1] row_mask:0xf bank_mask:0x2
v_mov_b32_dpp v108, v76 quad_perm:[0,0,0,0] row_mask:0xf bank_mask:0x4
v_mov_b32_dpp v109, v76 quad_perm:[0,0,0,0] row_mask:0xf bank_mask:0x8
v_mov_b32_dpp v110, v76 quad_perm:[1,1,1,1] row_mask:0xf bank_mask:0x4
v_mov_b32_dpp v111, v76 quad_perm:[1,1,1,1] row_mask:0xf bank_mask:0x8
v_smfmac_f32_16x16x64_bf16 v[8:11], v[104:107], v[40:47], v4
v_mov_b32_dpp v112, v76 quad_perm:[2,2,2,2] row_mask:0xf bank_mask:0x1
v_mov_b32_dpp v113, v76 quad_perm:[2,2,2,2] row_mask:0xf bank_mask:0x2
v_mov_b32_dpp v114, v76 quad_perm:[3,3,3,3] row_mask:0xf bank_mask:0x1
v_mov_b32_dpp v115, v76 quad_perm:[3,3,3,3] row_mask:0xf bank_mask:0x2
v_smfmac_f32_16x16x64_bf16 v[8:11], v[108:111], v[56:63], v4
v_mov_b32_dpp v116, v76 quad_perm:[2,2,2,2] row_mask:0xf bank_mask:0x4
v_mov_b32_dpp v117, v76 quad_perm:[2,2,2,2] row_mask:0xf bank_mask:0x8
v_mov_b32_dpp v118, v76 quad_perm:[3,3,3,3] row_mask:0xf bank_mask:0x4
v_mov_b32_dpp v119, v76 quad_perm:[3,3,3,3] row_mask:0xf bank_mask:0x8
v_smfmac_f32_16x16x64_bf16 v[8:11], v[112:115], v[48:55], v4
s_nop 0
v_smfmac_f32_16x16x64_bf16 v[8:11], v[116:119], v[64:71], v4
s_nop 7
ds_write_b128 v26, v[8:11] offset:8192
s_setprio 3
s_waitcnt lgkmcnt(0)
s_barrier
s_cmp_ge_u32 s3, 2
s_cbranch_scc1 L_nored_75
ds_read_b64 v[88:89], v3 offset:0
ds_read_b64 v[90:91], v3 offset:1024
ds_read_b64 v[92:93], v3 offset:2048
ds_read_b64 v[94:95], v3 offset:3072
ds_read_b64 v[96:97], v3 offset:4096
ds_read_b64 v[98:99], v3 offset:5120
ds_read_b64 v[100:101], v3 offset:6144
ds_read_b64 v[102:103], v3 offset:7168
s_waitcnt lgkmcnt(4)
v_pk_add_f32 v[88:89], v[88:89], v[90:91]
v_pk_add_f32 v[92:93], v[92:93], v[94:95]
s_waitcnt lgkmcnt(0)
v_pk_add_f32 v[96:97], v[96:97], v[98:99]
v_pk_add_f32 v[100:101], v[100:101], v[102:103]
v_pk_add_f32 v[88:89], v[88:89], v[92:93]
v_pk_add_f32 v[96:97], v[96:97], v[100:101]
v_pk_add_f32 v[88:89], v[88:89], v[96:97]
v_cvt_pk_bf16_f32 v88, v88, v89
v_min_u32 v88, -2, v88
buffer_store_dword v88, v23, s[64:67], s11 offen sc1
L_nored_75:
s_cmp_lg_u32 s3, 2
s_cbranch_scc1 L_noflag
s_mov_b64 exec, 1
buffer_store_dword v6, off, s[64:67], s12
s_mov_b64 exec, -1
L_noflag:
s_setprio 2
s_cmp_lg_u32 s51, 0
s_cbranch_scc1 L_dne
s_add_u32 s95, s8, 0
buffer_load_dwordx4 v[136:139], v24, s[56:59], s95 offen nt
s_add_u32 s95, s8, 4096
buffer_load_dwordx4 v[140:143], v24, s[56:59], s95 offen nt
L_dne:
s_add_u32 s95, s8, 16384
buffer_load_dwordx4 v[144:147], v24, s[56:59], s95 offen nt
s_add_u32 s95, s8, 20480
buffer_load_dwordx4 v[148:151], v24, s[56:59], s95 offen nt
s_add_u32 s95, s8, 32768
buffer_load_dwordx4 v[152:155], v24, s[56:59], s95 offen nt
s_add_u32 s95, s8, 36864
buffer_load_dwordx4 v[156:159], v24, s[56:59], s95 offen nt
s_add_u32 s95, s8, 49152
buffer_load_dwordx4 v[160:163], v24, s[56:59], s95 offen nt
s_add_u32 s95, s8, 53248
buffer_load_dwordx4 v[164:167], v24, s[56:59], s95 offen nt
s_setprio 0
s_waitcnt vmcnt(0)
v_add_u32 v3, 49152, v25
s_mov_b32 s18, s19
buffer_load_dwordx4 v[88:91], v34, s[64:67], s18 offen offset:0 sc1
buffer_load_dwordx4 v[92:95], v34, s[64:67], s18 offen offset:1024 sc1
s_waitcnt vmcnt(0)
s_mov_b32 s91, 0
L_retry_76:
v_max3_u32 v0, v88, v89, v90
v_max3_u32 v0, v0, v91, v92
v_max3_u32 v0, v0, v93, v94
v_max_u32 v0, v0, v95
v_cmp_eq_u32 vcc, -1, v0
s_cbranch_vccz L_ok_77
s_add_u32 s91, s91, 1
s_cmp_gt_u32 s91, 60000
s_cbranch_scc1 L_end
s_and_b32 s18, s91, 127
s_cmp_eq_u32 s18, 0
s_cselect_b32 s18, s20, s19
s_mov_b64 exec, vcc
buffer_load_dwordx4 v[88:91], v34, s[64:67], s18 offen offset:0 sc1
buffer_load_dwordx4 v[92:95], v34, s[64:67], s18 offen offset:1024 sc1
s_waitcnt vmcnt(0)
s_branch L_retry_76
L_pad2019:
s_branch L_pad1902
L_ok_77:
s_mov_b64 exec, -1
v_permlane32_swap_b32 v88, v90
v_permlane32_swap_b32 v89, v91
v_permlane32_swap_b32 v92, v94
v_permlane32_swap_b32 v93, v95
v_pk_add_f32 v[88:89], v[88:89], v[90:91]
v_pk_add_f32 v[92:93], v[92:93], v[94:95]
s_nop 0
v_permlane16_swap_b32 v88, v89
v_permlane16_swap_b32 v92, v93
v_add_f32 v78, v88, v89
v_add_f32 v79, v92, v93
s_nop 0
v_add_f32_dpp v78, v78, v78 row_ror:8 row_mask:0xf bank_mask:0xf
v_add_f32_dpp v79, v79, v79 row_ror:8 row_mask:0xf bank_mask:0xf
v_mul_f32 v80, 0xbfb8aa3b, v78
v_exp_f32 v80, v80
v_mul_f32 v78, v78, v79
v_add_f32 v80, 1.0, v80
v_rcp_f32 v80, v80
s_nop 0
v_mul_f32 v78, v78, v80
v_cvt_pk_bf16_f32 v78, v78, 0
s_nop 1
v_mov_b32_dpp v120, v78 row_newbcast:0 row_mask:0xf bank_mask:0x1
v_mov_b32_dpp v121, v78 row_newbcast:0 row_mask:0xf bank_mask:0x2
v_mov_b32_dpp v122, v78 row_newbcast:1 row_mask:0xf bank_mask:0x1
v_mov_b32_dpp v123, v78 row_newbcast:1 row_mask:0xf bank_mask:0x2
v_mov_b32_dpp v124, v78 row_newbcast:2 row_mask:0xf bank_mask:0x1
v_mov_b32_dpp v125, v78 row_newbcast:2 row_mask:0xf bank_mask:0x2
v_mov_b32_dpp v126, v78 row_newbcast:3 row_mask:0xf bank_mask:0x1
v_mov_b32_dpp v127, v78 row_newbcast:3 row_mask:0xf bank_mask:0x2
v_smfmac_f32_16x16x64_bf16 v[36:39], v[120:123], v[136:143], v4
v_mov_b32_dpp v128, v78 row_newbcast:4 row_mask:0xf bank_mask:0x1
v_mov_b32_dpp v129, v78 row_newbcast:4 row_mask:0xf bank_mask:0x2
v_mov_b32_dpp v130, v78 row_newbcast:5 row_mask:0xf bank_mask:0x1
v_mov_b32_dpp v131, v78 row_newbcast:5 row_mask:0xf bank_mask:0x2
v_smfmac_f32_16x16x64_bf16 v[36:39], v[124:127], v[144:151], v4
v_mov_b32_dpp v132, v78 row_newbcast:6 row_mask:0xf bank_mask:0x1
v_mov_b32_dpp v133, v78 row_newbcast:6 row_mask:0xf bank_mask:0x2
v_mov_b32_dpp v134, v78 row_newbcast:7 row_mask:0xf bank_mask:0x1
v_mov_b32_dpp v135, v78 row_newbcast:7 row_mask:0xf bank_mask:0x2
v_smfmac_f32_16x16x64_bf16 v[36:39], v[128:131], v[152:159], v4
s_nop 0
v_smfmac_f32_16x16x64_bf16 v[36:39], v[132:135], v[160:167], v4
s_mov_b32 exec_hi, 0
s_nop 6
ds_write_b128 v26, v[36:39] offset:49152
s_mov_b64 exec, -1
s_waitcnt lgkmcnt(0)
s_barrier
s_cmp_ge_u32 s3, 1
s_cbranch_scc1 L_nored_78
ds_read_b64 v[88:89], v3 offset:0
ds_read_b64 v[90:91], v3 offset:1024
ds_read_b64 v[92:93], v3 offset:2048
ds_read_b64 v[94:95], v3 offset:3072
ds_read_b64 v[96:97], v3 offset:4096
ds_read_b64 v[98:99], v3 offset:5120
ds_read_b64 v[100:101], v3 offset:6144
ds_read_b64 v[102:103], v3 offset:7168
s_waitcnt lgkmcnt(4)
v_pk_add_f32 v[88:89], v[88:89], v[90:91]
v_pk_add_f32 v[92:93], v[92:93], v[94:95]
s_waitcnt lgkmcnt(0)
v_pk_add_f32 v[96:97], v[96:97], v[98:99]
v_pk_add_f32 v[100:101], v[100:101], v[102:103]
v_pk_add_f32 v[88:89], v[88:89], v[92:93]
v_pk_add_f32 v[96:97], v[96:97], v[100:101]
v_pk_add_f32 v[88:89], v[88:89], v[96:97]
v_cvt_pk_bf16_f32 v88, v88, v89
v_min_u32 v88, -2, v88
buffer_store_dword v88, v23, s[64:67], s49 offen sc1
L_nored_78:
s_cmp_lg_u32 s3, 1
s_cbranch_scc1 L_noflag2
s_mov_b64 exec, 1
buffer_store_dword v6, off, s[64:67], s12 offset:1024
s_mov_b64 exec, -1
L_noflag2:
s_nop 0
L_end_x:
s_branch L_fin
.p2alignl 12, 0xbf810000
L_pad2103:
s_branch L_pad2019
L_tail_y:
ds_read_b32 v29, v76 offset:0
ds_read_b32 v30, v76 offset:512
ds_read_b32 v31, v76 offset:1024
ds_read_b32 v32, v76 offset:1536
s_add_u32 s95, s6, 0
buffer_load_dwordx4 v[136:139], v22, s[52:55], s95 offen nt
buffer_load_dwordx4 v[152:155], v2, s[52:55], s95 offen nt
s_add_u32 s95, s6, 14336
buffer_load_dwordx4 v[140:143], v22, s[52:55], s95 offen nt
buffer_load_dwordx4 v[156:159], v2, s[52:55], s95 offen nt
s_add_u32 s95, s6, 57344
buffer_load_dwordx4 v[144:147], v22, s[52:55], s95 offen nt
buffer_load_dwordx4 v[160:163], v2, s[52:55], s95 offen nt
s_add_u32 s95, s6, 71680
buffer_load_dwordx4 v[148:151], v22, s[52:55], s95 offen nt
buffer_load_dwordx4 v[164:167], v2, s[52:55], s95 offen nt
v_mov_b32 v18, v76
v_lshrrev_b32 v19, 4, v1
v_lshlrev_b32 v19, 3, v19
s_add_u32 s94, s8, 32768
v_add_u32 v84, 65536, v26
s_lshl_b32 s92, s3, 14
s_add_u32 s92, s92, 40960
v_add_u32 v85, s92, v25
v_mov_b64 v[96:97], 0
v_mov_b64 v[98:99], 0
v_mov_b64 v[100:101], 0
v_mov_b64 v[102:103], 0
v_mov_b64 v[104:105], 0
v_mov_b64 v[106:107], 0
v_mov_b64 v[108:109], 0
v_mov_b64 v[110:111], 0
v_mov_b64 v[112:113], 0
v_mov_b64 v[114:115], 0
v_mov_b64 v[116:117], 0
v_mov_b64 v[118:119], 0
v_mov_b64 v[120:121], 0
v_mov_b64 v[122:123], 0
v_mov_b64 v[124:125], 0
v_mov_b64 v[126:127], 0
v_mov_b64 v[128:129], 0
v_mov_b64 v[130:131], 0
v_mov_b64 v[132:133], 0
v_mov_b64 v[134:135], 0
s_waitcnt lgkmcnt(0)
v_mov_b64 v[72:73], 0
v_mov_b64 v[74:75], 0
v_mov_b64 v[76:77], 0
v_mov_b64 v[78:79], 0
v_cvt_pk_bf16_f32 v12, v31, 0
v_cvt_pk_bf16_f32 v13, v30, 0
s_nop 1
v_mov_b32_dpp v12, v13 quad_perm:[0,1,2,3] row_mask:0xf bank_mask:0xc
s_nop 1
v_mov_b32_dpp v112, v12 quad_perm:[0,0,0,0] row_mask:0xf bank_mask:0x5
v_mov_b32_dpp v113, v12 quad_perm:[0,0,0,0] row_mask:0xf bank_mask:0xa
v_mov_b32_dpp v114, v12 quad_perm:[1,1,1,1] row_mask:0xf bank_mask:0x5
v_mov_b32_dpp v115, v12 quad_perm:[1,1,1,1] row_mask:0xf bank_mask:0xa
v_mov_b32_dpp v116, v12 quad_perm:[2,2,2,2] row_mask:0xf bank_mask:0x5
v_mov_b32_dpp v117, v12 quad_perm:[2,2,2,2] row_mask:0xf bank_mask:0xa
v_mov_b32_dpp v118, v12 quad_perm:[3,3,3,3] row_mask:0xf bank_mask:0x5
v_mov_b32_dpp v119, v12 quad_perm:[3,3,3,3] row_mask:0xf bank_mask:0xa
v_bfe_u32 v12, v1, 1, 3
v_and_b32 v13, 1, v1
v_lshlrev_b32 v13, 4, v13
v_mov_b32 v14, 0x3f80
v_lshlrev_b32 v13, v13, v14
v_cmp_eq_u32 vcc, 0, v12
s_nop 1
v_cndmask_b32 v8, 0, v13, vcc
v_cmp_eq_u32 vcc, 1, v12
s_nop 1
v_cndmask_b32 v9, 0, v13, vcc
v_cmp_eq_u32 vcc, 2, v12
s_nop 1
v_cndmask_b32 v10, 0, v13, vcc
v_cmp_eq_u32 vcc, 3, v12
s_nop 1
v_cndmask_b32 v11, 0, v13, vcc
s_waitcnt vmcnt(9)
v_smfmac_f32_16x16x64_bf16 v[96:99], v[112:115], v[40:47], v4
v_smfmac_f32_16x16x64_bf16 v[100:103], v[112:115], v[56:63], v4
v_smfmac_f32_16x16x64_bf16 v[96:99], v[116:119], v[48:55], v4
v_smfmac_f32_16x16x64_bf16 v[100:103], v[116:119], v[64:71], v4
s_nop 6
ds_write_b128 v26, v[96:99] offset:40960
ds_write_b128 v26, v[100:103] offset:57344
s_mov_b32 s91, 0
L_lw_79:
ds_read_b32 v0, v5 offset:44
s_waitcnt lgkmcnt(0)
v_cmp_gt_u32 vcc, 1, v0
s_cbranch_vccz L_lwok_80
s_add_u32 s91, s91, 1
s_cmp_gt_u32 s91, 960000
s_cbranch_scc1 L_end
s_sleep 1
s_branch L_lw_79
L_lwok_80:
s_setprio 3
buffer_load_dwordx4 v[88:91], v20, s[64:67], s10 offen sc1
s_waitcnt vmcnt(5)
v_smfmac_f32_16x16x64_bf16 v[104:107], v[112:115], v[136:143], v4
v_smfmac_f32_16x16x64_bf16 v[108:111], v[112:115], v[152:159], v4
s_waitcnt vmcnt(1)
v_smfmac_f32_16x16x64_bf16 v[104:107], v[116:119], v[144:151], v4
v_smfmac_f32_16x16x64_bf16 v[108:111], v[116:119], v[160:167], v4
s_nop 6
ds_write_b128 v84, v[104:107] offset:8192
ds_write_b128 v84, v[108:111] offset:24576
s_waitcnt vmcnt(0)
s_mov_b32 s91, 0
L_retry_81:
v_mfma_f32_16x16x32_bf16 v[92:95], v[8:11], v[88:91], 0
v_max3_u32 v0, v88, v89, v90
v_max_u32 v0, v0, v91
v_cmp_eq_u32 vcc, -1, v0
s_cbranch_vccz L_ok_82
s_add_u32 s91, s91, 1
s_cmp_gt_u32 s91, 60000
s_cbranch_scc1 L_end
s_sleep 2
s_mov_b64 exec, vcc
buffer_load_dwordx4 v[88:91], v20, s[64:67], s10 offen sc1
s_mov_b64 exec, -1
s_nop 1
s_waitcnt vmcnt(0)
s_branch L_retry_81
L_pad2232:
s_branch L_pad2103
L_ok_82:
s_mov_b32 exec_hi, 0
s_nop 2
ds_write_b128 v16, v[92:95]
s_mov_b64 exec, -1
s_waitcnt lgkmcnt(0)
s_barrier
ds_read2_b32 v[92:93], v17 offset0:0 offset1:136
s_waitcnt lgkmcnt(0)
v_add_f32 v12, v92, v93
s_nop 1
v_add_f32_dpp v12, v12, v12 row_ror:8 row_mask:0xf bank_mask:0xf
s_nop 1
v_add_f32_dpp v12, v12, v12 row_ror:4 row_mask:0xf bank_mask:0xf
v_fma_f32 v12, v12, v29, v28
v_cvt_pk_bf16_f32 v12, v12, v12
v_lshlrev_b32 v33, 16, v12
v_mul_f32 v15, v33, v33
v_mul_f32 v12, v33, v31
v_add_f32_dpp v14, v33, v33 quad_perm:[1,0,3,2] row_mask:0xf bank_mask:0xf
v_add_f32_dpp v15, v15, v15 quad_perm:[1,0,3,2] row_mask:0xf bank_mask:0xf
v_and_b32 v13, 0xffff0000, v12
v_add_f32_dpp v14, v14, v14 quad_perm:[2,3,0,1] row_mask:0xf bank_mask:0xf
v_add_f32_dpp v15, v15, v15 quad_perm:[2,3,0,1] row_mask:0xf bank_mask:0xf
s_mov_b32 exec_lo, 0x00010001
s_mov_b32 exec_hi, 0x00010001
v_min_u32 v14, -2, v14
v_min_u32 v15, -2, v15
buffer_store_dwordx2 v[14:15], v19, s[64:67], s8 offen
s_mov_b64 exec, -1
s_setprio 0
ds_write_b32 v18, v33
v_sub_f32 v12, v12, v13
v_cvt_pk_bf16_f32 v12, v12, v13
s_nop 1
v_mov_b32_dpp v120, v12 quad_perm:[0,0,0,0] row_mask:0xf bank_mask:0x1
v_mov_b32_dpp v121, v12 quad_perm:[0,0,0,0] row_mask:0xf bank_mask:0x2
v_mov_b32_dpp v122, v12 quad_perm:[1,1,1,1] row_mask:0xf bank_mask:0x1
v_mov_b32_dpp v123, v12 quad_perm:[1,1,1,1] row_mask:0xf bank_mask:0x2
v_mov_b32_dpp v124, v12 quad_perm:[0,0,0,0] row_mask:0xf bank_mask:0x4
v_mov_b32_dpp v125, v12 quad_perm:[0,0,0,0] row_mask:0xf bank_mask:0x8
v_mov_b32_dpp v126, v12 quad_perm:[1,1,1,1] row_mask:0xf bank_mask:0x4
v_mov_b32_dpp v127, v12 quad_perm:[1,1,1,1] row_mask:0xf bank_mask:0x8
v_smfmac_f32_16x16x64_bf16 v[72:75], v[120:123], v[40:47], v4
v_smfmac_f32_16x16x64_bf16 v[76:79], v[120:123], v[136:143], v4
v_mov_b32_dpp v128, v12 quad_perm:[2,2,2,2] row_mask:0xf bank_mask:0x1
v_mov_b32_dpp v129, v12 quad_perm:[2,2,2,2] row_mask:0xf bank_mask:0x2
v_mov_b32_dpp v130, v12 quad_perm:[3,3,3,3] row_mask:0xf bank_mask:0x1
v_mov_b32_dpp v131, v12 quad_perm:[3,3,3,3] row_mask:0xf bank_mask:0x2
v_smfmac_f32_16x16x64_bf16 v[72:75], v[124:127], v[56:63], v4
v_smfmac_f32_16x16x64_bf16 v[76:79], v[124:127], v[152:159], v4
v_mov_b32_dpp v132, v12 quad_perm:[2,2,2,2] row_mask:0xf bank_mask:0x4
v_mov_b32_dpp v133, v12 quad_perm:[2,2,2,2] row_mask:0xf bank_mask:0x8
v_mov_b32_dpp v134, v12 quad_perm:[3,3,3,3] row_mask:0xf bank_mask:0x4
v_mov_b32_dpp v135, v12 quad_perm:[3,3,3,3] row_mask:0xf bank_mask:0x8
v_smfmac_f32_16x16x64_bf16 v[72:75], v[128:131], v[48:55], v4
v_smfmac_f32_16x16x64_bf16 v[76:79], v[128:131], v[144:151], v4
v_smfmac_f32_16x16x64_bf16 v[72:75], v[132:135], v[64:71], v4
v_smfmac_f32_16x16x64_bf16 v[76:79], v[132:135], v[160:167], v4
s_nop 6
ds_write_b128 v26, v[72:75] offset:8192
ds_write_b128 v26, v[76:79] offset:24576
s_mov_b32 exec_lo, 0x00010001
s_mov_b32 exec_hi, 0x00010001
buffer_store_dwordx2 v[14:15], v19, s[64:67], s94 offen sc1
s_mov_b64 exec, -1
s_cmp_ge_u32 s3, 4
s_cbranch_scc1 L_noearly2
ds_read2st64_b64 v[96:99], v85 offset0:0 offset1:1
ds_read2st64_b64 v[100:103], v85 offset0:2 offset1:3
ds_read2st64_b64 v[104:107], v85 offset0:4 offset1:5
ds_read2st64_b64 v[108:111], v85 offset0:6 offset1:7
ds_read2st64_b64 v[112:115], v85 offset0:8 offset1:9
ds_read2st64_b64 v[116:119], v85 offset0:10 offset1:11
ds_read2st64_b64 v[8:11], v85 offset0:12 offset1:13
ds_read2st64_b64 v[36:39], v85 offset0:14 offset1:15
s_waitcnt lgkmcnt(0)
v_pk_add_f32 v[96:97], v[96:97], v[100:101]
v_pk_add_f32 v[104:105], v[104:105], v[108:109]
v_pk_add_f32 v[112:113], v[112:113], v[116:117]
v_pk_add_f32 v[8:9], v[8:9], v[36:37]
v_pk_add_f32 v[96:97], v[96:97], v[104:105]
v_pk_add_f32 v[112:113], v[112:113], v[8:9]
v_pk_add_f32 v[80:81], v[96:97], v[112:113]
v_pk_add_f32 v[98:99], v[98:99], v[102:103]
v_pk_add_f32 v[106:107], v[106:107], v[110:111]
v_pk_add_f32 v[114:115], v[114:115], v[118:119]
v_pk_add_f32 v[10:11], v[10:11], v[38:39]
v_pk_add_f32 v[98:99], v[98:99], v[106:107]
v_pk_add_f32 v[114:115], v[114:115], v[10:11]
v_pk_add_f32 v[82:83], v[98:99], v[114:115]
L_noearly2:
s_waitcnt lgkmcnt(0)
s_barrier
s_cmp_ge_u32 s3, 4
s_cbranch_scc1 L_pc_done
ds_read_b64 v[88:89], v3 offset:0
ds_read_b64 v[90:91], v3 offset:1024
ds_read_b64 v[92:93], v3 offset:2048
ds_read_b64 v[94:95], v3 offset:3072
ds_read_b64 v[96:97], v3 offset:4096
ds_read_b64 v[98:99], v3 offset:5120
ds_read_b64 v[100:101], v3 offset:6144
ds_read_b64 v[102:103], v3 offset:7168
ds_read_b64 v[12:13], v5 offset:512
s_waitcnt lgkmcnt(5)
v_pk_add_f32 v[88:89], v[88:89], v[90:91]
v_pk_add_f32 v[92:93], v[92:93], v[94:95]
v_pk_add_f32 v[88:89], v[88:89], v[92:93]
s_waitcnt lgkmcnt(0)
v_pk_fma_f32 v[88:89], v[80:81], v[12:13], v[88:89] op_sel:[0,0,0] op_sel_hi:[1,0,1]
v_pk_add_f32 v[96:97], v[96:97], v[98:99]
v_pk_add_f32 v[100:101], v[100:101], v[102:103]
v_pk_add_f32 v[96:97], v[96:97], v[100:101]
v_pk_add_f32 v[88:89], v[88:89], v[96:97]
v_pk_fma_f32 v[88:89], v[88:89], v[12:13], v[82:83] op_sel:[0,1,0] op_sel_hi:[1,1,1]
v_min_u32 v92, -2, v88
v_min_u32 v93, -2, v89
v_min_u32_dpp v94, v88, v35 quad_perm:[1,1,3,3] row_mask:0xf bank_mask:0xf
v_min_u32_dpp v95, v89, v35 quad_perm:[1,1,3,3] row_mask:0xf bank_mask:0xf
s_mov_b64 exec, s[16:17]
buffer_store_dwordx4 v[92:95], v25, s[64:67], s11 offen
buffer_store_dwordx4 v[92:95], v25, s[64:67], s49 offen sc1
s_mov_b64 exec, -1
L_pc_done:
s_cmp_lg_u32 s90, s88
s_cbranch_scc1 L_fin
s_branch L_dd
L_pad2360:
s_branch L_pad2232
L_dd:
s_cmp_lg_u32 s3, 7
s_cbranch_scc1 L_fin
s_lshl_b32 s92, s88, 12
s_add_u32 s92, s92, 1490944
s_lshl_b32 s93, s88, 8
v_and_b32 v12, 0x1ff, v26
v_add_u32 v13, 139520, v12
ds_read_b128 v[88:91], v13
ds_read_b128 v[92:95], v13 offset:1536
v_lshrrev_b32 v12, 1, v12
s_mov_b32 s91, 0
s_mov_b64 exec, 0xffff
L_hint2:
buffer_load_dword v14, v23, s[64:67], s12 offen offset:1024 sc1
s_add_u32 s91, s91, 1
s_cmp_gt_u32 s91, 128
s_waitcnt vmcnt(0)
v_cmp_eq_u32 vcc, -1, v14
s_sleep 2
s_cbranch_scc1 L_hint2_end
s_cbranch_vccnz L_hint2
L_hint2_end:
s_mov_b64 exec, -1
buffer_load_dwordx4 v[40:43], v20, s[64:67], s92 offen offset:0 sc1
buffer_load_dwordx4 v[44:47], v20, s[64:67], s92 offen offset:1024 sc1
buffer_load_dwordx4 v[48:51], v20, s[64:67], s92 offen offset:2048 sc1
buffer_load_dwordx4 v[52:55], v20, s[64:67], s92 offen offset:3072 sc1
s_waitcnt lgkmcnt(0)
s_waitcnt vmcnt(0)
s_mov_b32 s91, 0
L_retry_83:
v_mfma_f32_16x16x32_bf16 v[72:75], v[8:11], v[40:43], 0
v_mfma_f32_16x16x32_bf16 v[72:75], v[8:11], v[44:47], v[72:75]
v_mfma_f32_16x16x32_bf16 v[72:75], v[8:11], v[48:51], v[72:75]
v_mfma_f32_16x16x32_bf16 v[72:75], v[8:11], v[52:55], v[72:75]
v_max3_u32 v0, v40, v41, v42
v_max3_u32 v0, v0, v43, v44
v_max3_u32 v0, v0, v45, v46
v_max3_u32 v0, v0, v47, v48
v_max3_u32 v0, v0, v49, v50
v_max3_u32 v0, v0, v51, v52
v_max3_u32 v0, v0, v53, v54
v_max_u32 v0, v0, v55
v_cmp_eq_u32 vcc, -1, v0
s_cbranch_vccz L_ok_84
s_add_u32 s91, s91, 1
s_cmp_gt_u32 s91, 60000
s_cbranch_scc1 L_end
s_sleep 1
s_mov_b64 exec, vcc
buffer_load_dwordx4 v[40:43], v20, s[64:67], s92 offen offset:0 sc1
buffer_load_dwordx4 v[44:47], v20, s[64:67], s92 offen offset:1024 sc1
buffer_load_dwordx4 v[48:51], v20, s[64:67], s92 offen offset:2048 sc1
buffer_load_dwordx4 v[52:55], v20, s[64:67], s92 offen offset:3072 sc1
s_mov_b64 exec, -1
s_nop 1
s_waitcnt vmcnt(0)
s_branch L_retry_83
L_ok_84:
v_pk_fma_f32 v[72:73], v[72:73], v[92:93], v[88:89]
v_pk_fma_f32 v[74:75], v[74:75], v[94:95], v[90:91]
v_cvt_pk_bf16_f32 v72, v72, v73
v_cvt_pk_bf16_f32 v73, v74, v75
s_mov_b32 exec_hi, 0
buffer_store_dwordx2 v[72:73], v12, s[76:79], s93 offen
s_mov_b64 exec, -1
L_fin:
s_nop 0
L_end_y:
s_endpgm
L_chain:
s_setprio 3
s_add_u32 s3, s3, 4
v_and_b32 v1, 63, v0
s_mov_b32 s62, 12582912
s_mov_b32 s63, 0x20000
s_mov_b32 s74, 2048
s_mov_b32 s75, 0x20000
v_and_b32 v34, 3, v1
v_lshlrev_b32 v36, 4, v33
v_mul_u32_u24 v37, 12288, v32
v_add_u32 v37, v37, v36
v_lshl_add_u32 v27, v34, 2, v32
v_lshlrev_b32 v27, 1, v27
v_lshlrev_b32 v39, 4, v1
s_lshr_b32 s90, s2, 1
s_lshr_b32 s96, s2, 6
s_and_b32 s92, s90, 15
s_lshr_b32 s93, s90, 4
s_add_u32 s97, s93, 4
s_lshl_b32 s94, s93, 2
s_add_u32 s94, s94, s3
s_sub_u32 s94, s94, 16
s_lshl_b32 s94, s94, 1
s_and_b32 s95, s2, 1
s_cselect_b32 s95, 0, 32
s_sub_u32 s100, s90, s95
s_lshr_b32 s93, s100, 4
s_lshl_b32 s95, s93, 2
s_add_u32 s95, s95, s3
s_add_u32 s95, s95, 32
s_and_b32 s51, s2, 0x81
s_cmp_lg_u32 s51, 0x80
s_cselect_b32 s94, s95, s94
s_cselect_b32 s93, s93, s97
s_cselect_b32 s97, 536870912, 0
s_cselect_b32 s51, s96, 0
v_or_b32 v35, s97, v37
s_mul_i32 s86, s94, 196608
s_lshl_b32 s95, s94, 5
s_lshl_b32 s94, s92, 8
s_add_u32 s86, s86, s94
s_mul_i32 s92, s92, 12
s_add_u32 s92, s92, s93
s_lshl_b32 s49, s92, 9
s_cmp_eq_u32 s96, 0
s_waitcnt lgkmcnt(0)
s_mov_b32 s72, s22
s_mov_b32 s60, s24
s_cbranch_scc1 L_nom0
s_and_b32 s73, s23, 0xffff
s_and_b32 s61, s25, 0xffff
buffer_load_ushort v16, v27, s[72:75], s95 offen
buffer_load_ushort v17, v27, s[72:75], s95 offen offset:32
buffer_load_dwordx4 v[40:43], v37, s[60:63], s86 offen nt
s_add_u32 s86, s86, 49152
buffer_load_dwordx4 v[44:47], v37, s[60:63], s86 offen nt
s_add_u32 s86, s86, 49152
buffer_load_dwordx4 v[48:51], v37, s[60:63], s86 offen nt
s_add_u32 s86, s86, 49152
buffer_load_dwordx4 v[52:55], v37, s[60:63], s86 offen nt
s_add_u32 s86, s86, 49152
buffer_load_dwordx4 v[56:59], v35, s[60:63], s86 offen nt
s_add_u32 s86, s86, 49152
buffer_load_dwordx4 v[60:63], v35, s[60:63], s86 offen nt
s_add_u32 s86, s86, 49152
buffer_load_dwordx4 v[64:67], v35, s[60:63], s86 offen nt
s_add_u32 s86, s86, 49152
buffer_load_dwordx4 v[68:71], v35, s[60:63], s86 offen nt
L_nom0:
v_mov_b32 v5, 138240
v_mov_b32 v6, 1
s_and_b32 s87, s2, 7
s_bfe_u32 s88, s2, 0x30003
s_bfe_u32 s85, s2, 0x40003
s_lshr_b32 s89, s2, 7
s_mov_b32 s66, 268435456
s_mov_b32 s67, 0x20000
s_mov_b32 s70, 2048
s_mov_b32 s71, 0x20000
s_mov_b32 s42, 8388608
s_mov_b32 s43, 0x20000
s_mov_b32 s82, 256
s_mov_b32 s83, 0x20000
s_and_b32 s73, s23, 0xffff
s_mov_b32 s68, s4
s_and_b32 s69, s5, 0xffff
s_mov_b32 s64, s30
s_and_b32 s65, s31, 0xffff
s_mov_b32 s80, s28
s_and_b32 s81, s29, 0xffff
s_mov_b32 s23, s3
v_mov_b32 v28, -1
v_mov_b32 v29, -1
v_mov_b32 v30, -1
v_mov_b32 v31, -1
s_cmp_eq_u32 s51, 0
s_cbranch_scc1 L_noclr
s_lshl_b32 s92, s100, 2
s_add_u32 s92, s92, s3
s_mul_i32 s92, s92, 2816
s_add_u32 s92, s92, 180224
buffer_store_dwordx4 v[28:31], v39, s[64:67], s92 offen offset:0 sc1
buffer_store_dwordx4 v[28:31], v39, s[64:67], s92 offen offset:1024 sc1
s_mov_b32 exec_hi, 0xffff
buffer_store_dwordx4 v[28:31], v39, s[64:67], s92 offen offset:2048 sc1
s_mov_b64 exec, -1
L_noclr:
s_barrier
s_and_b32 s84, s90, 3
s_lshr_b32 s92, s90, 2
s_xor_b32 s93, s92, 16
s_sub_u32 s94, s92, 8
s_cmp_lg_u32 s51, 0
s_cselect_b32 s93, s94, s93
s_mul_i32 s94, s93, 11
s_lshr_b32 s94, s94, 5
s_add_u32 s93, s93, s94
s_and_b32 s94, s93, 3
s_addc_u32 s93, s93, 0
s_and_b32 s94, s92, 7
s_lshl_b32 s94, s94, 2
s_add_u32 s94, s94, 1
s_and_b32 s92, s2, 0x81
s_cselect_b32 s93, s93, s94
s_lshl_b32 s92, s93, 2
s_add_u32 s92, s92, s84
s_lshl_b32 s50, s92, 9
s_lshl_b32 s92, s84, 2
s_add_u32 s92, s92, s3
s_lshl_b32 s14, s92, 7
s_lshl_b32 s93, s93, 8
s_cmp_lg_u32 s51, 0
s_cselect_b32 s40, s24, s10
s_cselect_b32 s41, s25, s11
s_cselect_b32 s42, 12582912, s42
s_cselect_b32 s94, 4096, 0
s_mov_b32 s101, 8192
s_cselect_b32 s101, 12288, s101
s_mov_b32 s95, 98304
s_cselect_b32 s95, 770048, s95
s_and_b32 s41, s41, 0xffff
s_add_u32 s50, s50, s95
v_mad_u32_u24 v38, v32, s101, v36
s_mul_i32 s100, s92, s101
s_lshl_b32 s100, s100, 6
s_add_u32 s100, s100, s93
s_add_u32 s100, s100, s94
s_lshl_b32 s101, s101, 2
v_lshrrev_b32 v12, 1, v33
v_and_b32 v13, 1, v33
v_lshlrev_b32 v13, 4, v13
v_mov_b32 v14, 0xffff
v_lshlrev_b32 v13, v13, v14
v_cmp_eq_u32 vcc, 0, v12
s_nop 1
v_cndmask_b32 v8, 0, v13, vcc
v_cmp_eq_u32 vcc, 1, v12
s_nop 1
v_cndmask_b32 v9, 0, v13, vcc
v_cmp_eq_u32 vcc, 2, v12
s_nop 1
v_cndmask_b32 v10, 0, v13, vcc
v_cmp_eq_u32 vcc, 3, v12
s_nop 1
v_cndmask_b32 v11, 0, v13, vcc
v_lshlrev_b32 v25, 3, v1
s_lshl_b32 s92, s3, 9
v_lshlrev_b32 v26, 5, v33
v_lshl_add_u32 v26, v32, 4, v26
v_add_u32 v26, s92, v26
s_cmp_eq_u32 s96, 0
s_cbranch_scc1 L_nom0b
s_waitcnt vmcnt(8)
v_lshlrev_b32 v16, 16, v16
s_mov_b32 s94, 0xbfb8aa3b
v_max_f32 v14, 0xc2b00000, v16
v_min_f32 v14, 0x42c80000, v14
v_mul_f32 v12, s94, v14
v_fma_f32 v13, v14, s94, -v12
v_fmac_f32 v13, 0xb2a57060, v14
v_exp_f32 v12, v12
v_mul_f32 v13, 0x3f317218, v13
v_fmac_f32 v12, v12, v13
v_add_f32 v12, 1.0, v12
v_rcp_f32 v13, v12
s_nop 0
v_fma_f32 v14, -v12, v13, 1.0
v_fmac_f32 v13, v14, v13
v_mul_f32 v14, v16, v13
v_fma_f32 v15, -v12, v14, v16
v_fmac_f32 v14, v15, v13
v_fma_f32 v15, -v12, v14, v16
v_fma_f32 v16, v15, v13, v14
v_cvt_pk_bf16_f32 v16, v16, v16
v_lshlrev_b32 v17, 16, v17
s_mov_b32 s94, 0xbfb8aa3b
v_max_f32 v14, 0xc2b00000, v17
v_min_f32 v14, 0x42c80000, v14
v_mul_f32 v12, s94, v14
v_fma_f32 v13, v14, s94, -v12
v_fmac_f32 v13, 0xb2a57060, v14
v_exp_f32 v12, v12
v_mul_f32 v13, 0x3f317218, v13
v_fmac_f32 v12, v12, v13
v_add_f32 v12, 1.0, v12
v_rcp_f32 v13, v12
s_nop 0
v_fma_f32 v14, -v12, v13, 1.0
v_fmac_f32 v13, v14, v13
v_mul_f32 v14, v17, v13
v_fma_f32 v15, -v12, v14, v17
v_fmac_f32 v14, v15, v13
v_fma_f32 v15, -v12, v14, v17
v_fma_f32 v17, v15, v13, v14
v_cvt_pk_bf16_f32 v17, v17, v17
v_and_b32_dpp v136, v16, v8 quad_perm:[0,0,0,0] row_mask:0xf bank_mask:0xf
v_and_b32_dpp v137, v16, v9 quad_perm:[0,0,0,0] row_mask:0xf bank_mask:0xf
v_and_b32_dpp v138, v16, v10 quad_perm:[0,0,0,0] row_mask:0xf bank_mask:0xf
v_and_b32_dpp v139, v16, v11 quad_perm:[0,0,0,0] row_mask:0xf bank_mask:0xf
v_and_b32_dpp v140, v16, v8 quad_perm:[1,1,1,1] row_mask:0xf bank_mask:0xf
v_and_b32_dpp v141, v16, v9 quad_perm:[1,1,1,1] row_mask:0xf bank_mask:0xf
v_and_b32_dpp v142, v16, v10 quad_perm:[1,1,1,1] row_mask:0xf bank_mask:0xf
v_and_b32_dpp v143, v16, v11 quad_perm:[1,1,1,1] row_mask:0xf bank_mask:0xf
v_and_b32_dpp v144, v16, v8 quad_perm:[2,2,2,2] row_mask:0xf bank_mask:0xf
v_and_b32_dpp v145, v16, v9 quad_perm:[2,2,2,2] row_mask:0xf bank_mask:0xf
v_and_b32_dpp v146, v16, v10 quad_perm:[2,2,2,2] row_mask:0xf bank_mask:0xf
v_and_b32_dpp v147, v16, v11 quad_perm:[2,2,2,2] row_mask:0xf bank_mask:0xf
v_and_b32_dpp v148, v16, v8 quad_perm:[3,3,3,3] row_mask:0xf bank_mask:0xf
v_and_b32_dpp v149, v16, v9 quad_perm:[3,3,3,3] row_mask:0xf bank_mask:0xf
v_and_b32_dpp v150, v16, v10 quad_perm:[3,3,3,3] row_mask:0xf bank_mask:0xf
v_and_b32_dpp v151, v16, v11 quad_perm:[3,3,3,3] row_mask:0xf bank_mask:0xf
v_and_b32_dpp v152, v17, v8 quad_perm:[0,0,0,0] row_mask:0xf bank_mask:0xf
v_and_b32_dpp v153, v17, v9 quad_perm:[0,0,0,0] row_mask:0xf bank_mask:0xf
v_and_b32_dpp v154, v17, v10 quad_perm:[0,0,0,0] row_mask:0xf bank_mask:0xf
v_and_b32_dpp v155, v17, v11 quad_perm:[0,0,0,0] row_mask:0xf bank_mask:0xf
v_and_b32_dpp v156, v17, v8 quad_perm:[1,1,1,1] row_mask:0xf bank_mask:0xf
v_and_b32_dpp v157, v17, v9 quad_perm:[1,1,1,1] row_mask:0xf bank_mask:0xf
v_and_b32_dpp v158, v17, v10 quad_perm:[1,1,1,1] row_mask:0xf bank_mask:0xf
v_and_b32_dpp v159, v17, v11 quad_perm:[1,1,1,1] row_mask:0xf bank_mask:0xf
v_and_b32_dpp v160, v17, v8 quad_perm:[2,2,2,2] row_mask:0xf bank_mask:0xf
v_and_b32_dpp v161, v17, v9 quad_perm:[2,2,2,2] row_mask:0xf bank_mask:0xf
v_and_b32_dpp v162, v17, v10 quad_perm:[2,2,2,2] row_mask:0xf bank_mask:0xf
v_and_b32_dpp v163, v17, v11 quad_perm:[2,2,2,2] row_mask:0xf bank_mask:0xf
v_and_b32_dpp v164, v17, v8 quad_perm:[3,3,3,3] row_mask:0xf bank_mask:0xf
v_and_b32_dpp v165, v17, v9 quad_perm:[3,3,3,3] row_mask:0xf bank_mask:0xf
v_and_b32_dpp v166, v17, v10 quad_perm:[3,3,3,3] row_mask:0xf bank_mask:0xf
v_and_b32_dpp v167, v17, v11 quad_perm:[3,3,3,3] row_mask:0xf bank_mask:0xf
s_waitcnt vmcnt(0)
v_mfma_f32_16x16x32_bf16 v[28:31], v[136:139], v[40:43], 0
v_mfma_f32_16x16x32_bf16 v[28:31], v[140:143], v[44:47], v[28:31]
v_mfma_f32_16x16x32_bf16 v[28:31], v[144:147], v[48:51], v[28:31]
v_mfma_f32_16x16x32_bf16 v[28:31], v[148:151], v[52:55], v[28:31]
v_mfma_f32_16x16x32_bf16 v[28:31], v[152:155], v[56:59], v[28:31]
v_mfma_f32_16x16x32_bf16 v[28:31], v[156:159], v[60:63], v[28:31]
v_mfma_f32_16x16x32_bf16 v[28:31], v[160:163], v[64:67], v[28:31]
v_mfma_f32_16x16x32_bf16 v[28:31], v[164:167], v[68:71], v[28:31]
s_mov_b32 exec_hi, 0
v_add_u32 v2, 131072, v26
s_nop 5
ds_write_b128 v2, v[28:31]
s_mov_b64 exec, -1
s_waitcnt lgkmcnt(0)
s_waitcnt lgkmcnt(0)
s_mov_b64 exec, 1
ds_add_u32 v5, v6 offset:0
s_mov_b64 exec, -1
s_cmp_lg_u32 s3, 0
s_cbranch_scc1 L_nom0b
s_load_dword s92, s[28:29], 0
s_waitcnt lgkmcnt(0)
s_cmp_ge_u32 s92, 16
s_cbranch_scc1 L_cntok_85
s_sleep 8
s_load_dword s92, s[28:29], 64
s_waitcnt lgkmcnt(0)
s_cmp_ge_u32 s92, 16
s_cbranch_scc1 L_cntok_85
s_sleep 8
s_load_dword s92, s[28:29], 128
s_waitcnt lgkmcnt(0)
s_cmp_ge_u32 s92, 16
s_cbranch_scc1 L_cntok_85
s_sleep 8
s_load_dword s92, s[28:29], 192
s_waitcnt lgkmcnt(0)
s_cmp_ge_u32 s92, 16
s_cbranch_scc1 L_cntok_85
s_mov_b32 s91, 0
v_mov_b32 v12, 0
L_cnt_86:
s_sleep 16
buffer_load_dword v13, v12, s[80:83], 0 offen sc1
s_waitcnt vmcnt(0)
v_cmp_gt_u32 vcc, 16, v13
s_cbranch_vccz L_cntok_85
s_add_u32 s91, s91, 1
s_cmp_gt_u32 s91, 60000
s_cbranch_scc1 L_end
s_branch L_cnt_86
L_cntok_85:
s_waitcnt lgkmcnt(0)
s_mov_b64 exec, 1
ds_add_u32 v5, v6 offset:4
s_mov_b64 exec, -1
s_cmp_lg_u32 s3, 0
s_cbranch_scc1 L_nored_87
s_mov_b32 s91, 0
L_lw_88:
ds_read_b32 v0, v5 offset:0
s_waitcnt lgkmcnt(0)
v_cmp_gt_u32 vcc, 4, v0
s_cbranch_vccz L_lwok_89
s_add_u32 s91, s91, 1
s_cmp_gt_u32 s91, 960000
s_cbranch_scc1 L_end
s_branch L_lw_88
L_lwok_89:
v_add_u32 v2, 131072, v25
ds_read2st64_b64 v[12:15], v2 offset0:0 offset1:1
ds_read2st64_b64 v[16:19], v2 offset0:2 offset1:3
s_waitcnt lgkmcnt(0)
v_pk_add_f32 v[12:13], v[12:13], v[14:15]
v_pk_add_f32 v[16:17], v[16:17], v[18:19]
v_pk_add_f32 v[12:13], v[12:13], v[16:17]
v_min_u32 v12, -2, v12
v_min_u32 v13, -2, v13
s_nop 0
v_mov_b32_dpp v14, v12 quad_perm:[1,1,3,3] row_mask:0xf bank_mask:0xf
v_mov_b32_dpp v15, v13 quad_perm:[1,1,3,3] row_mask:0xf bank_mask:0xf
s_mov_b32 exec_lo, 0x55555555
s_mov_b32 exec_hi, 0x55555555
buffer_store_dwordx4 v[12:15], v25, s[64:67], s49 offen sc1
s_mov_b64 exec, -1
L_nored_87:
L_nom0b:
s_cmp_lg_u32 s51, 0
s_cselect_b32 s68, s72, s68
s_cselect_b32 s69, s73, s69
v_lshlrev_b32 v35, 5, v1
v_and_b32 v30, 7, v1
v_lshl_add_u32 v31, v30, 2, v32
v_lshlrev_b32 v31, 1, v31
buffer_load_ushort v20, v31, s[68:71], s14 offen offset:0
buffer_load_ushort v21, v31, s[68:71], s14 offen offset:64
buffer_load_dwordx4 v[136:139], v35, s[68:71], 0 offen
buffer_load_dwordx4 v[140:143], v35, s[68:71], 0 offen offset:16
buffer_load_dwordx4 v[72:75], v38, s[40:43], s100 offen nt
s_add_u32 s100, s100, s101
buffer_load_dwordx4 v[76:79], v38, s[40:43], s100 offen nt
s_add_u32 s100, s100, s101
buffer_load_dwordx4 v[80:83], v38, s[40:43], s100 offen nt
s_add_u32 s100, s100, s101
buffer_load_dwordx4 v[84:87], v38, s[40:43], s100 offen nt
s_add_u32 s100, s100, s101
buffer_load_dwordx4 v[88:91], v38, s[40:43], s100 offen nt
s_add_u32 s100, s100, s101
buffer_load_dwordx4 v[92:95], v38, s[40:43], s100 offen nt
s_add_u32 s100, s100, s101
buffer_load_dwordx4 v[96:99], v38, s[40:43], s100 offen nt
s_add_u32 s100, s100, s101
buffer_load_dwordx4 v[100:103], v38, s[40:43], s100 offen nt
s_add_u32 s100, s100, s101
buffer_load_dwordx4 v[104:107], v38, s[40:43], s100 offen nt
s_add_u32 s100, s100, s101
buffer_load_dwordx4 v[108:111], v38, s[40:43], s100 offen nt
s_add_u32 s100, s100, s101
buffer_load_dwordx4 v[112:115], v38, s[40:43], s100 offen nt
s_add_u32 s100, s100, s101
buffer_load_dwordx4 v[116:119], v38, s[40:43], s100 offen nt
s_add_u32 s100, s100, s101
buffer_load_dwordx4 v[120:123], v38, s[40:43], s100 offen nt
s_add_u32 s100, s100, s101
buffer_load_dwordx4 v[124:127], v38, s[40:43], s100 offen nt
s_add_u32 s100, s100, s101
buffer_load_dwordx4 v[128:131], v38, s[40:43], s100 offen nt
s_add_u32 s100, s100, s101
buffer_load_dwordx4 v[132:135], v38, s[40:43], s100 offen nt
s_or_b32 s92, s96, s3
s_cbranch_scc1 L_nocnt2
s_load_dword s92, s[28:29], 0
s_waitcnt lgkmcnt(0)
s_cmp_ge_u32 s92, 16
s_cbranch_scc1 L_cntok_90
s_sleep 8
s_load_dword s92, s[28:29], 64
s_waitcnt lgkmcnt(0)
s_cmp_ge_u32 s92, 16
s_cbranch_scc1 L_cntok_90
s_sleep 8
s_load_dword s92, s[28:29], 128
s_waitcnt lgkmcnt(0)
s_cmp_ge_u32 s92, 16
s_cbranch_scc1 L_cntok_90
s_sleep 8
s_load_dword s92, s[28:29], 192
s_waitcnt lgkmcnt(0)
s_cmp_ge_u32 s92, 16
s_cbranch_scc1 L_cntok_90
s_mov_b32 s91, 0
v_mov_b32 v12, 0
L_cnt_91:
s_sleep 16
buffer_load_dword v13, v12, s[80:83], 0 offen sc1
s_waitcnt vmcnt(0)
v_cmp_gt_u32 vcc, 16, v13
s_cbranch_vccz L_cntok_90
s_add_u32 s91, s91, 1
s_cmp_gt_u32 s91, 60000
s_cbranch_scc1 L_end
s_branch L_cnt_91
L_cntok_90:
s_waitcnt lgkmcnt(0)
s_mov_b64 exec, 1
ds_add_u32 v5, v6 offset:4
s_mov_b64 exec, -1
L_nocnt2:
s_waitcnt vmcnt(16)
v_lshlrev_b32 v20, 16, v20
v_lshlrev_b32 v21, 16, v21
s_cmp_lg_u32 s51, 0
s_cbranch_scc1 L_chain_m
v_lshlrev_b32 v144, 16, v136
v_and_b32 v145, 0xffff0000, v136
v_lshlrev_b32 v146, 16, v137
v_and_b32 v147, 0xffff0000, v137
v_lshlrev_b32 v148, 16, v138
v_and_b32 v149, 0xffff0000, v138
v_lshlrev_b32 v150, 16, v139
v_and_b32 v151, 0xffff0000, v139
v_lshlrev_b32 v152, 16, v140
v_and_b32 v153, 0xffff0000, v140
v_lshlrev_b32 v154, 16, v141
v_and_b32 v155, 0xffff0000, v141
v_lshlrev_b32 v156, 16, v142
v_and_b32 v157, 0xffff0000, v142
v_lshlrev_b32 v158, 16, v143
v_and_b32 v159, 0xffff0000, v143
v_add_f32 v28, v144, v145
v_add_f32 v28, v28, v146
v_add_f32 v28, v28, v147
v_add_f32 v28, v28, v148
v_add_f32 v28, v28, v149
v_add_f32 v28, v28, v150
v_add_f32 v28, v28, v151
v_add_f32 v28, v28, v152
v_add_f32 v28, v28, v153
v_add_f32 v28, v28, v154
v_add_f32 v28, v28, v155
v_add_f32 v28, v28, v156
v_add_f32 v28, v28, v157
v_add_f32 v28, v28, v158
v_add_f32 v28, v28, v159
s_nop 1
v_add_f32_dpp v28, v28, v28 quad_perm:[1,0,3,2] row_mask:0xf bank_mask:0xf
s_nop 1
v_add_f32_dpp v28, v28, v28 quad_perm:[2,3,0,1] row_mask:0xf bank_mask:0xf
s_nop 1
v_add_f32_dpp v28, v28, v28 row_ror:8 row_mask:0xf bank_mask:0xf
s_nop 1
v_add_f32_dpp v28, v28, v28 row_ror:4 row_mask:0xf bank_mask:0xf
v_mov_b32 v12, v28
s_nop 1
v_permlane16_swap_b32 v12, v28
v_add_f32 v28, v28, v12
v_mov_b32 v12, v28
s_nop 1
v_permlane32_swap_b32 v12, v28
v_add_f32 v28, v28, v12
v_mul_f32 v28, 0x3a800000, v28
v_sub_f32 v144, v144, v28
v_sub_f32 v145, v145, v28
v_sub_f32 v146, v146, v28
v_sub_f32 v147, v147, v28
v_sub_f32 v148, v148, v28
v_sub_f32 v149, v149, v28
v_sub_f32 v150, v150, v28
v_sub_f32 v151, v151, v28
v_sub_f32 v152, v152, v28
v_sub_f32 v153, v153, v28
v_sub_f32 v154, v154, v28
v_sub_f32 v155, v155, v28
v_sub_f32 v156, v156, v28
v_sub_f32 v157, v157, v28
v_sub_f32 v158, v158, v28
v_sub_f32 v159, v159, v28
v_mul_f32 v29, v144, v144
v_fmac_f32 v29, v145, v145
v_fmac_f32 v29, v146, v146
v_fmac_f32 v29, v147, v147
v_fmac_f32 v29, v148, v148
v_fmac_f32 v29, v149, v149
v_fmac_f32 v29, v150, v150
v_fmac_f32 v29, v151, v151
v_fmac_f32 v29, v152, v152
v_fmac_f32 v29, v153, v153
v_fmac_f32 v29, v154, v154
v_fmac_f32 v29, v155, v155
v_fmac_f32 v29, v156, v156
v_fmac_f32 v29, v157, v157
v_fmac_f32 v29, v158, v158
v_fmac_f32 v29, v159, v159
s_nop 1
v_add_f32_dpp v29, v29, v29 quad_perm:[1,0,3,2] row_mask:0xf bank_mask:0xf
s_nop 1
v_add_f32_dpp v29, v29, v29 quad_perm:[2,3,0,1] row_mask:0xf bank_mask:0xf
s_nop 1
v_add_f32_dpp v29, v29, v29 row_ror:8 row_mask:0xf bank_mask:0xf
s_nop 1
v_add_f32_dpp v29, v29, v29 row_ror:4 row_mask:0xf bank_mask:0xf
v_mov_b32 v12, v29
s_nop 1
v_permlane16_swap_b32 v12, v29
v_add_f32 v29, v29, v12
v_mov_b32 v12, v29
s_nop 1
v_permlane32_swap_b32 v12, v29
v_add_f32 v29, v29, v12
v_mul_f32 v29, 0x3a800000, v29
v_cvt_pk_bf16_f32 v29, v29, v29
v_and_b32 v29, 0xffff0000, v29
v_add_f32 v29, 925353388, v29
v_cvt_pk_bf16_f32 v29, v29, v29
v_and_b32 v29, 0xffff0000, v29
v_sqrt_f32 v29, v29
v_cvt_pk_bf16_f32 v28, v28, v28
v_and_b32 v28, 0xffff0000, v28
v_cvt_pk_bf16_f32 v29, v29, v29
v_and_b32 v29, 0xffff0000, v29
v_rcp_f32 v29, v29
v_lshrrev_b32 v12, 3, v1
v_lshlrev_b32 v12, 9, v12
v_lshl_add_u32 v30, v30, 4, v12
v_lshrrev_b32 v13, 5, v1
v_lshl_add_u32 v31, v13, 29, v30
v_add_u32 v31, 4096, v31
s_lshl_b32 s92, s84, 1
s_lshr_b32 s93, s3, 1
s_add_u32 s92, s92, s93
s_mul_i32 s92, s92, 6144
s_and_b32 s93, s3, 1
s_lshl_b32 s93, s93, 8
s_add_u32 s14, s92, s93
s_add_u32 s15, s14, 49152
s_waitcnt vmcnt(0)
s_mov_b32 s91, 0
L_lw_92:
ds_read_b32 v0, v5 offset:4
s_waitcnt lgkmcnt(0)
v_cmp_gt_u32 vcc, 1, v0
s_cbranch_vccz L_lwok_93
s_add_u32 s91, s91, 1
s_cmp_gt_u32 s91, 960000
s_cbranch_scc1 L_end
s_branch L_lw_92
L_lwok_93:
buffer_load_dwordx4 v[40:43], v30, s[64:67], s14 offen offset:0 sc1
buffer_load_dwordx4 v[44:47], v30, s[64:67], s14 offen offset:128 sc1
buffer_load_dwordx4 v[48:51], v30, s[64:67], s15 offen offset:0 sc1
buffer_load_dwordx4 v[52:55], v30, s[64:67], s15 offen offset:128 sc1
buffer_load_dwordx4 v[56:59], v31, s[64:67], s14 offen offset:0 sc1
buffer_load_dwordx4 v[60:63], v31, s[64:67], s14 offen offset:128 sc1
buffer_load_dwordx4 v[64:67], v31, s[64:67], s15 offen offset:0 sc1
buffer_load_dwordx4 v[68:71], v31, s[64:67], s15 offen offset:128 sc1
s_waitcnt vmcnt(0)
s_mov_b32 s91, 0
L_retry_94:
v_max3_u32 v0, v40, v41, v42
v_max3_u32 v0, v0, v43, v44
v_max3_u32 v0, v0, v45, v46
v_max3_u32 v0, v0, v47, v48
v_max3_u32 v0, v0, v49, v50
v_max3_u32 v0, v0, v51, v52
v_max3_u32 v0, v0, v53, v54
v_max3_u32 v0, v0, v55, v56
v_max3_u32 v0, v0, v57, v58
v_max3_u32 v0, v0, v59, v60
v_max3_u32 v0, v0, v61, v62
v_max3_u32 v0, v0, v63, v64
v_max3_u32 v0, v0, v65, v66
v_max3_u32 v0, v0, v67, v68
v_max3_u32 v0, v0, v69, v70
v_max_u32 v0, v0, v71
v_cmp_eq_u32 vcc, -1, v0
s_cbranch_vccz L_ok_95
s_add_u32 s91, s91, 1
s_cmp_gt_u32 s91, 60000
s_cbranch_scc1 L_end
s_sleep 16
s_mov_b64 exec, vcc
buffer_load_dwordx4 v[40:43], v30, s[64:67], s14 offen offset:0 sc1
buffer_load_dwordx4 v[44:47], v30, s[64:67], s14 offen offset:128 sc1
buffer_load_dwordx4 v[48:51], v30, s[64:67], s15 offen offset:0 sc1
buffer_load_dwordx4 v[52:55], v30, s[64:67], s15 offen offset:128 sc1
buffer_load_dwordx4 v[56:59], v31, s[64:67], s14 offen offset:0 sc1
buffer_load_dwordx4 v[60:63], v31, s[64:67], s14 offen offset:128 sc1
buffer_load_dwordx4 v[64:67], v31, s[64:67], s15 offen offset:0 sc1
buffer_load_dwordx4 v[68:71], v31, s[64:67], s15 offen offset:128 sc1
s_waitcnt vmcnt(0)
s_branch L_retry_94
L_ok_95:
s_mov_b64 exec, -1
v_pk_add_f32 v[40:41], v[40:41], v[56:57]
v_pk_add_f32 v[42:43], v[42:43], v[58:59]
v_pk_add_f32 v[44:45], v[44:45], v[60:61]
v_pk_add_f32 v[46:47], v[46:47], v[62:63]
v_pk_add_f32 v[48:49], v[48:49], v[64:65]
v_pk_add_f32 v[50:51], v[50:51], v[66:67]
v_pk_add_f32 v[52:53], v[52:53], v[68:69]
v_pk_add_f32 v[54:55], v[54:55], v[70:71]
v_permlane32_swap_b32 v40, v42
v_permlane32_swap_b32 v41, v43
v_permlane32_swap_b32 v44, v46
v_permlane32_swap_b32 v45, v47
v_permlane32_swap_b32 v48, v50
v_permlane32_swap_b32 v49, v51
v_permlane32_swap_b32 v52, v54
v_permlane32_swap_b32 v53, v55
v_pk_add_f32 v[40:41], v[40:41], v[42:43]
v_pk_add_f32 v[44:45], v[44:45], v[46:47]
v_pk_add_f32 v[48:49], v[48:49], v[50:51]
v_pk_add_f32 v[52:53], v[52:53], v[54:55]
v_permlane16_swap_b32 v40, v41
v_permlane16_swap_b32 v44, v45
v_permlane16_swap_b32 v48, v49
v_permlane16_swap_b32 v52, v53
v_add_f32 v136, v40, v41
v_add_f32 v137, v44, v45
v_add_f32 v138, v48, v49
v_add_f32 v139, v52, v53
v_add_f32_dpp v136, v136, v136 row_ror:8 row_mask:0xf bank_mask:0xf
v_add_f32_dpp v137, v137, v137 row_ror:8 row_mask:0xf bank_mask:0xf
v_add_f32_dpp v138, v138, v138 row_ror:8 row_mask:0xf bank_mask:0xf
v_add_f32_dpp v139, v139, v139 row_ror:8 row_mask:0xf bank_mask:0xf
v_cvt_pk_bf16_f32 v136, v136, v136
v_and_b32 v136, 0xffff0000, v136
v_cvt_pk_bf16_f32 v137, v137, v137
v_and_b32 v137, 0xffff0000, v137
v_cvt_pk_bf16_f32 v138, v138, v138
v_and_b32 v138, 0xffff0000, v138
v_cvt_pk_bf16_f32 v139, v139, v139
v_and_b32 v139, 0xffff0000, v139
v_add_f32 v138, 1.0, v138
v_cvt_pk_bf16_f32 v138, v138, v138
v_and_b32 v138, 0xffff0000, v138
v_sub_f32 v141, v20, v28
v_cvt_pk_bf16_f32 v141, v141, v141
v_and_b32 v141, 0xffff0000, v141
v_mul_f32 v141, v141, v29
v_cvt_pk_bf16_f32 v141, v141, v141
v_and_b32 v141, 0xffff0000, v141
v_mul_f32 v141, v141, v138
v_cvt_pk_bf16_f32 v141, v141, v141
v_and_b32 v141, 0xffff0000, v141
v_add_f32 v141, v141, v136
v_cvt_pk_bf16_f32 v20, v141, v141
v_add_f32 v139, 1.0, v139
v_cvt_pk_bf16_f32 v139, v139, v139
v_and_b32 v139, 0xffff0000, v139
v_sub_f32 v141, v21, v28
v_cvt_pk_bf16_f32 v141, v141, v141
v_and_b32 v141, 0xffff0000, v141
v_mul_f32 v141, v141, v29
v_cvt_pk_bf16_f32 v141, v141, v141
v_and_b32 v141, 0xffff0000, v141
v_mul_f32 v141, v141, v139
v_cvt_pk_bf16_f32 v141, v141, v141
v_and_b32 v141, 0xffff0000, v141
v_add_f32 v141, v141, v137
v_cvt_pk_bf16_f32 v21, v141, v141
v_and_b32_dpp v40, v20, v8 row_newbcast:0 row_mask:0xf bank_mask:0xf
v_and_b32_dpp v41, v20, v9 row_newbcast:0 row_mask:0xf bank_mask:0xf
v_and_b32_dpp v42, v20, v10 row_newbcast:0 row_mask:0xf bank_mask:0xf
v_and_b32_dpp v43, v20, v11 row_newbcast:0 row_mask:0xf bank_mask:0xf
v_and_b32_dpp v44, v20, v8 row_newbcast:1 row_mask:0xf bank_mask:0xf
v_and_b32_dpp v45, v20, v9 row_newbcast:1 row_mask:0xf bank_mask:0xf
v_and_b32_dpp v46, v20, v10 row_newbcast:1 row_mask:0xf bank_mask:0xf
v_and_b32_dpp v47, v20, v11 row_newbcast:1 row_mask:0xf bank_mask:0xf
v_and_b32_dpp v48, v20, v8 row_newbcast:2 row_mask:0xf bank_mask:0xf
v_and_b32_dpp v49, v20, v9 row_newbcast:2 row_mask:0xf bank_mask:0xf
v_and_b32_dpp v50, v20, v10 row_newbcast:2 row_mask:0xf bank_mask:0xf
v_and_b32_dpp v51, v20, v11 row_newbcast:2 row_mask:0xf bank_mask:0xf
v_and_b32_dpp v52, v20, v8 row_newbcast:3 row_mask:0xf bank_mask:0xf
v_and_b32_dpp v53, v20, v9 row_newbcast:3 row_mask:0xf bank_mask:0xf
v_and_b32_dpp v54, v20, v10 row_newbcast:3 row_mask:0xf bank_mask:0xf
v_and_b32_dpp v55, v20, v11 row_newbcast:3 row_mask:0xf bank_mask:0xf
v_mfma_f32_16x16x32_bf16 v[160:163], v[40:43], v[72:75], 0
v_mfma_f32_16x16x32_bf16 v[160:163], v[44:47], v[76:79], v[160:163]
v_mfma_f32_16x16x32_bf16 v[160:163], v[48:51], v[80:83], v[160:163]
v_mfma_f32_16x16x32_bf16 v[160:163], v[52:55], v[84:87], v[160:163]
v_and_b32_dpp v144, v20, v8 row_newbcast:4 row_mask:0xf bank_mask:0xf
v_and_b32_dpp v145, v20, v9 row_newbcast:4 row_mask:0xf bank_mask:0xf
v_and_b32_dpp v146, v20, v10 row_newbcast:4 row_mask:0xf bank_mask:0xf
v_and_b32_dpp v147, v20, v11 row_newbcast:4 row_mask:0xf bank_mask:0xf
v_and_b32_dpp v148, v20, v8 row_newbcast:5 row_mask:0xf bank_mask:0xf
v_and_b32_dpp v149, v20, v9 row_newbcast:5 row_mask:0xf bank_mask:0xf
v_and_b32_dpp v150, v20, v10 row_newbcast:5 row_mask:0xf bank_mask:0xf
v_and_b32_dpp v151, v20, v11 row_newbcast:5 row_mask:0xf bank_mask:0xf
v_and_b32_dpp v152, v20, v8 row_newbcast:6 row_mask:0xf bank_mask:0xf
v_and_b32_dpp v153, v20, v9 row_newbcast:6 row_mask:0xf bank_mask:0xf
v_and_b32_dpp v154, v20, v10 row_newbcast:6 row_mask:0xf bank_mask:0xf
v_and_b32_dpp v155, v20, v11 row_newbcast:6 row_mask:0xf bank_mask:0xf
v_and_b32_dpp v156, v20, v8 row_newbcast:7 row_mask:0xf bank_mask:0xf
v_and_b32_dpp v157, v20, v9 row_newbcast:7 row_mask:0xf bank_mask:0xf
v_and_b32_dpp v158, v20, v10 row_newbcast:7 row_mask:0xf bank_mask:0xf
v_and_b32_dpp v159, v20, v11 row_newbcast:7 row_mask:0xf bank_mask:0xf
v_mfma_f32_16x16x32_bf16 v[160:163], v[144:147], v[88:91], v[160:163]
v_mfma_f32_16x16x32_bf16 v[160:163], v[148:151], v[92:95], v[160:163]
v_mfma_f32_16x16x32_bf16 v[160:163], v[152:155], v[96:99], v[160:163]
v_mfma_f32_16x16x32_bf16 v[160:163], v[156:159], v[100:103], v[160:163]
v_and_b32_dpp v40, v21, v8 row_newbcast:0 row_mask:0xf bank_mask:0xf
v_and_b32_dpp v41, v21, v9 row_newbcast:0 row_mask:0xf bank_mask:0xf
v_and_b32_dpp v42, v21, v10 row_newbcast:0 row_mask:0xf bank_mask:0xf
v_and_b32_dpp v43, v21, v11 row_newbcast:0 row_mask:0xf bank_mask:0xf
v_and_b32_dpp v44, v21, v8 row_newbcast:1 row_mask:0xf bank_mask:0xf
v_and_b32_dpp v45, v21, v9 row_newbcast:1 row_mask:0xf bank_mask:0xf
v_and_b32_dpp v46, v21, v10 row_newbcast:1 row_mask:0xf bank_mask:0xf
v_and_b32_dpp v47, v21, v11 row_newbcast:1 row_mask:0xf bank_mask:0xf
v_and_b32_dpp v48, v21, v8 row_newbcast:2 row_mask:0xf bank_mask:0xf
v_and_b32_dpp v49, v21, v9 row_newbcast:2 row_mask:0xf bank_mask:0xf
v_and_b32_dpp v50, v21, v10 row_newbcast:2 row_mask:0xf bank_mask:0xf
v_and_b32_dpp v51, v21, v11 row_newbcast:2 row_mask:0xf bank_mask:0xf
v_and_b32_dpp v52, v21, v8 row_newbcast:3 row_mask:0xf bank_mask:0xf
v_and_b32_dpp v53, v21, v9 row_newbcast:3 row_mask:0xf bank_mask:0xf
v_and_b32_dpp v54, v21, v10 row_newbcast:3 row_mask:0xf bank_mask:0xf
v_and_b32_dpp v55, v21, v11 row_newbcast:3 row_mask:0xf bank_mask:0xf
v_mfma_f32_16x16x32_bf16 v[160:163], v[40:43], v[104:107], v[160:163]
v_mfma_f32_16x16x32_bf16 v[160:163], v[44:47], v[108:111], v[160:163]
v_mfma_f32_16x16x32_bf16 v[160:163], v[48:51], v[112:115], v[160:163]
v_mfma_f32_16x16x32_bf16 v[160:163], v[52:55], v[116:119], v[160:163]
v_and_b32_dpp v144, v21, v8 row_newbcast:4 row_mask:0xf bank_mask:0xf
v_and_b32_dpp v145, v21, v9 row_newbcast:4 row_mask:0xf bank_mask:0xf
v_and_b32_dpp v146, v21, v10 row_newbcast:4 row_mask:0xf bank_mask:0xf
v_and_b32_dpp v147, v21, v11 row_newbcast:4 row_mask:0xf bank_mask:0xf
v_and_b32_dpp v148, v21, v8 row_newbcast:5 row_mask:0xf bank_mask:0xf
v_and_b32_dpp v149, v21, v9 row_newbcast:5 row_mask:0xf bank_mask:0xf
v_and_b32_dpp v150, v21, v10 row_newbcast:5 row_mask:0xf bank_mask:0xf
v_and_b32_dpp v151, v21, v11 row_newbcast:5 row_mask:0xf bank_mask:0xf
v_and_b32_dpp v152, v21, v8 row_newbcast:6 row_mask:0xf bank_mask:0xf
v_and_b32_dpp v153, v21, v9 row_newbcast:6 row_mask:0xf bank_mask:0xf
v_and_b32_dpp v154, v21, v10 row_newbcast:6 row_mask:0xf bank_mask:0xf
v_and_b32_dpp v155, v21, v11 row_newbcast:6 row_mask:0xf bank_mask:0xf
v_and_b32_dpp v156, v21, v8 row_newbcast:7 row_mask:0xf bank_mask:0xf
v_and_b32_dpp v157, v21, v9 row_newbcast:7 row_mask:0xf bank_mask:0xf
v_and_b32_dpp v158, v21, v10 row_newbcast:7 row_mask:0xf bank_mask:0xf
v_and_b32_dpp v159, v21, v11 row_newbcast:7 row_mask:0xf bank_mask:0xf
v_mfma_f32_16x16x32_bf16 v[160:163], v[144:147], v[120:123], v[160:163]
v_mfma_f32_16x16x32_bf16 v[160:163], v[148:151], v[124:127], v[160:163]
v_mfma_f32_16x16x32_bf16 v[160:163], v[152:155], v[128:131], v[160:163]
v_mfma_f32_16x16x32_bf16 v[160:163], v[156:159], v[132:135], v[160:163]
s_mov_b32 exec_hi, 0
v_add_u32 v2, 133120, v26
s_nop 5
ds_write_b128 v2, v[160:163]
s_mov_b64 exec, -1
s_waitcnt lgkmcnt(0)
s_waitcnt lgkmcnt(0)
s_mov_b64 exec, 1
ds_add_u32 v5, v6 offset:8
s_mov_b64 exec, -1
s_cmp_lg_u32 s3, 0
s_cbranch_scc1 L_nored_96
s_mov_b32 s91, 0
L_lw_97:
ds_read_b32 v0, v5 offset:8
s_waitcnt lgkmcnt(0)
v_cmp_gt_u32 vcc, 4, v0
s_cbranch_vccz L_lwok_98
s_add_u32 s91, s91, 1
s_cmp_gt_u32 s91, 960000
s_cbranch_scc1 L_end
s_branch L_lw_97
L_lwok_98:
v_add_u32 v2, 133120, v25
ds_read2st64_b64 v[12:15], v2 offset0:0 offset1:1
ds_read2st64_b64 v[16:19], v2 offset0:2 offset1:3
s_waitcnt lgkmcnt(0)
v_pk_add_f32 v[12:13], v[12:13], v[14:15]
v_pk_add_f32 v[16:17], v[16:17], v[18:19]
v_pk_add_f32 v[12:13], v[12:13], v[16:17]
v_min_u32 v12, -2, v12
v_min_u32 v13, -2, v13
s_nop 0
v_mov_b32_dpp v14, v12 quad_perm:[1,1,3,3] row_mask:0xf bank_mask:0xf
v_mov_b32_dpp v15, v13 quad_perm:[1,1,3,3] row_mask:0xf bank_mask:0xf
s_mov_b32 exec_lo, 0x55555555
s_mov_b32 exec_hi, 0x55555555
buffer_store_dwordx4 v[12:15], v25, s[64:67], s50 offen sc1
s_mov_b64 exec, -1
L_nored_96:
s_branch L_h2
.p2alignl 12, 0xbf810000
L_chain_m:
s_mov_b32 s94, 0xbfb8aa3b
v_max_f32 v14, 0xc2b00000, v20
v_min_f32 v14, 0x42c80000, v14
v_mul_f32 v12, s94, v14
v_fma_f32 v13, v14, s94, -v12
v_fmac_f32 v13, 0xb2a57060, v14
v_exp_f32 v12, v12
v_mul_f32 v13, 0x3f317218, v13
v_fmac_f32 v12, v12, v13
v_add_f32 v12, 1.0, v12
v_rcp_f32 v13, v12
s_nop 0
v_fma_f32 v14, -v12, v13, 1.0
v_fmac_f32 v13, v14, v13
v_mul_f32 v14, v20, v13
v_fma_f32 v15, -v12, v14, v20
v_fmac_f32 v14, v15, v13
v_fma_f32 v15, -v12, v14, v20
v_fma_f32 v20, v15, v13, v14
v_cvt_pk_bf16_f32 v20, v20, v20
s_mov_b32 s94, 0xbfb8aa3b
v_max_f32 v14, 0xc2b00000, v21
v_min_f32 v14, 0x42c80000, v14
v_mul_f32 v12, s94, v14
v_fma_f32 v13, v14, s94, -v12
v_fmac_f32 v13, 0xb2a57060, v14
v_exp_f32 v12, v12
v_mul_f32 v13, 0x3f317218, v13
v_fmac_f32 v12, v12, v13
v_add_f32 v12, 1.0, v12
v_rcp_f32 v13, v12
s_nop 0
v_fma_f32 v14, -v12, v13, 1.0
v_fmac_f32 v13, v14, v13
v_mul_f32 v14, v21, v13
v_fma_f32 v15, -v12, v14, v21
v_fmac_f32 v14, v15, v13
v_fma_f32 v15, -v12, v14, v21
v_fma_f32 v21, v15, v13, v14
v_cvt_pk_bf16_f32 v21, v21, v21
v_and_b32_dpp v144, v20, v8 row_newbcast:0 row_mask:0xf bank_mask:0xf
v_and_b32_dpp v145, v20, v9 row_newbcast:0 row_mask:0xf bank_mask:0xf
v_and_b32_dpp v146, v20, v10 row_newbcast:0 row_mask:0xf bank_mask:0xf
v_and_b32_dpp v147, v20, v11 row_newbcast:0 row_mask:0xf bank_mask:0xf
v_and_b32_dpp v148, v20, v8 row_newbcast:1 row_mask:0xf bank_mask:0xf
v_and_b32_dpp v149, v20, v9 row_newbcast:1 row_mask:0xf bank_mask:0xf
v_and_b32_dpp v150, v20, v10 row_newbcast:1 row_mask:0xf bank_mask:0xf
v_and_b32_dpp v151, v20, v11 row_newbcast:1 row_mask:0xf bank_mask:0xf
v_and_b32_dpp v152, v20, v8 row_newbcast:2 row_mask:0xf bank_mask:0xf
v_and_b32_dpp v153, v20, v9 row_newbcast:2 row_mask:0xf bank_mask:0xf
v_and_b32_dpp v154, v20, v10 row_newbcast:2 row_mask:0xf bank_mask:0xf
v_and_b32_dpp v155, v20, v11 row_newbcast:2 row_mask:0xf bank_mask:0xf
v_and_b32_dpp v156, v20, v8 row_newbcast:3 row_mask:0xf bank_mask:0xf
v_and_b32_dpp v157, v20, v9 row_newbcast:3 row_mask:0xf bank_mask:0xf
v_and_b32_dpp v158, v20, v10 row_newbcast:3 row_mask:0xf bank_mask:0xf
v_and_b32_dpp v159, v20, v11 row_newbcast:3 row_mask:0xf bank_mask:0xf
s_waitcnt vmcnt(12)
v_mfma_f32_16x16x32_bf16 v[160:163], v[144:147], v[72:75], 0
v_mfma_f32_16x16x32_bf16 v[160:163], v[148:151], v[76:79], v[160:163]
v_mfma_f32_16x16x32_bf16 v[160:163], v[152:155], v[80:83], v[160:163]
v_mfma_f32_16x16x32_bf16 v[160:163], v[156:159], v[84:87], v[160:163]
v_and_b32_dpp v144, v20, v8 row_newbcast:4 row_mask:0xf bank_mask:0xf
v_and_b32_dpp v145, v20, v9 row_newbcast:4 row_mask:0xf bank_mask:0xf
v_and_b32_dpp v146, v20, v10 row_newbcast:4 row_mask:0xf bank_mask:0xf
v_and_b32_dpp v147, v20, v11 row_newbcast:4 row_mask:0xf bank_mask:0xf
v_and_b32_dpp v148, v20, v8 row_newbcast:5 row_mask:0xf bank_mask:0xf
v_and_b32_dpp v149, v20, v9 row_newbcast:5 row_mask:0xf bank_mask:0xf
v_and_b32_dpp v150, v20, v10 row_newbcast:5 row_mask:0xf bank_mask:0xf
v_and_b32_dpp v151, v20, v11 row_newbcast:5 row_mask:0xf bank_mask:0xf
v_and_b32_dpp v152, v20, v8 row_newbcast:6 row_mask:0xf bank_mask:0xf
v_and_b32_dpp v153, v20, v9 row_newbcast:6 row_mask:0xf bank_mask:0xf
v_and_b32_dpp v154, v20, v10 row_newbcast:6 row_mask:0xf bank_mask:0xf
v_and_b32_dpp v155, v20, v11 row_newbcast:6 row_mask:0xf bank_mask:0xf
v_and_b32_dpp v156, v20, v8 row_newbcast:7 row_mask:0xf bank_mask:0xf
v_and_b32_dpp v157, v20, v9 row_newbcast:7 row_mask:0xf bank_mask:0xf
v_and_b32_dpp v158, v20, v10 row_newbcast:7 row_mask:0xf bank_mask:0xf
v_and_b32_dpp v159, v20, v11 row_newbcast:7 row_mask:0xf bank_mask:0xf
s_waitcnt vmcnt(8)
v_mfma_f32_16x16x32_bf16 v[160:163], v[144:147], v[88:91], v[160:163]
v_mfma_f32_16x16x32_bf16 v[160:163], v[148:151], v[92:95], v[160:163]
v_mfma_f32_16x16x32_bf16 v[160:163], v[152:155], v[96:99], v[160:163]
v_mfma_f32_16x16x32_bf16 v[160:163], v[156:159], v[100:103], v[160:163]
v_and_b32_dpp v144, v21, v8 row_newbcast:0 row_mask:0xf bank_mask:0xf
v_and_b32_dpp v145, v21, v9 row_newbcast:0 row_mask:0xf bank_mask:0xf
v_and_b32_dpp v146, v21, v10 row_newbcast:0 row_mask:0xf bank_mask:0xf
v_and_b32_dpp v147, v21, v11 row_newbcast:0 row_mask:0xf bank_mask:0xf
v_and_b32_dpp v148, v21, v8 row_newbcast:1 row_mask:0xf bank_mask:0xf
v_and_b32_dpp v149, v21, v9 row_newbcast:1 row_mask:0xf bank_mask:0xf
v_and_b32_dpp v150, v21, v10 row_newbcast:1 row_mask:0xf bank_mask:0xf
v_and_b32_dpp v151, v21, v11 row_newbcast:1 row_mask:0xf bank_mask:0xf
v_and_b32_dpp v152, v21, v8 row_newbcast:2 row_mask:0xf bank_mask:0xf
v_and_b32_dpp v153, v21, v9 row_newbcast:2 row_mask:0xf bank_mask:0xf
v_and_b32_dpp v154, v21, v10 row_newbcast:2 row_mask:0xf bank_mask:0xf
v_and_b32_dpp v155, v21, v11 row_newbcast:2 row_mask:0xf bank_mask:0xf
v_and_b32_dpp v156, v21, v8 row_newbcast:3 row_mask:0xf bank_mask:0xf
v_and_b32_dpp v157, v21, v9 row_newbcast:3 row_mask:0xf bank_mask:0xf
v_and_b32_dpp v158, v21, v10 row_newbcast:3 row_mask:0xf bank_mask:0xf
v_and_b32_dpp v159, v21, v11 row_newbcast:3 row_mask:0xf bank_mask:0xf
s_waitcnt vmcnt(4)
v_mfma_f32_16x16x32_bf16 v[160:163], v[144:147], v[104:107], v[160:163]
v_mfma_f32_16x16x32_bf16 v[160:163], v[148:151], v[108:111], v[160:163]
v_mfma_f32_16x16x32_bf16 v[160:163], v[152:155], v[112:115], v[160:163]
v_mfma_f32_16x16x32_bf16 v[160:163], v[156:159], v[116:119], v[160:163]
v_and_b32_dpp v144, v21, v8 row_newbcast:4 row_mask:0xf bank_mask:0xf
v_and_b32_dpp v145, v21, v9 row_newbcast:4 row_mask:0xf bank_mask:0xf
v_and_b32_dpp v146, v21, v10 row_newbcast:4 row_mask:0xf bank_mask:0xf
v_and_b32_dpp v147, v21, v11 row_newbcast:4 row_mask:0xf bank_mask:0xf
v_and_b32_dpp v148, v21, v8 row_newbcast:5 row_mask:0xf bank_mask:0xf
v_and_b32_dpp v149, v21, v9 row_newbcast:5 row_mask:0xf bank_mask:0xf
v_and_b32_dpp v150, v21, v10 row_newbcast:5 row_mask:0xf bank_mask:0xf
v_and_b32_dpp v151, v21, v11 row_newbcast:5 row_mask:0xf bank_mask:0xf
v_and_b32_dpp v152, v21, v8 row_newbcast:6 row_mask:0xf bank_mask:0xf
v_and_b32_dpp v153, v21, v9 row_newbcast:6 row_mask:0xf bank_mask:0xf
v_and_b32_dpp v154, v21, v10 row_newbcast:6 row_mask:0xf bank_mask:0xf
v_and_b32_dpp v155, v21, v11 row_newbcast:6 row_mask:0xf bank_mask:0xf
v_and_b32_dpp v156, v21, v8 row_newbcast:7 row_mask:0xf bank_mask:0xf
v_and_b32_dpp v157, v21, v9 row_newbcast:7 row_mask:0xf bank_mask:0xf
v_and_b32_dpp v158, v21, v10 row_newbcast:7 row_mask:0xf bank_mask:0xf
v_and_b32_dpp v159, v21, v11 row_newbcast:7 row_mask:0xf bank_mask:0xf
s_waitcnt vmcnt(0)
v_mfma_f32_16x16x32_bf16 v[160:163], v[144:147], v[120:123], v[160:163]
v_mfma_f32_16x16x32_bf16 v[160:163], v[148:151], v[124:127], v[160:163]
v_mfma_f32_16x16x32_bf16 v[160:163], v[152:155], v[128:131], v[160:163]
v_mfma_f32_16x16x32_bf16 v[160:163], v[156:159], v[132:135], v[160:163]
s_mov_b32 exec_hi, 0
v_add_u32 v2, 133120, v26
s_nop 5
ds_write_b128 v2, v[160:163]
s_mov_b64 exec, -1
s_waitcnt lgkmcnt(0)
s_waitcnt lgkmcnt(0)
s_mov_b64 exec, 1
ds_add_u32 v5, v6 offset:8
s_mov_b64 exec, -1
s_mov_b32 s91, 0
L_lw_99:
ds_read_b32 v0, v5 offset:4
s_waitcnt lgkmcnt(0)
v_cmp_gt_u32 vcc, 1, v0
s_cbranch_vccz L_lwok_100
s_add_u32 s91, s91, 1
s_cmp_gt_u32 s91, 960000
s_cbranch_scc1 L_end
s_branch L_lw_99
L_lwok_100:
L_h2:
s_and_b32 s84, s2, 3
v_lshrrev_b32 v32, 5, v1
v_and_b32 v33, 31, v1
v_lshlrev_b32 v34, 4, v33
v_lshl_add_u32 v37, v32, 3, v34
v_lshrrev_b32 v38, 1, v37
s_mul_i32 s92, s3, 544
s_add_u32 s92, s92, 135168
v_add_u32 v38, s92, v38
s_lshl_b32 s92, s3, 9
s_add_u32 s92, s92, 139520
v_add_u32 v37, s92, v37
s_lshl_b32 s92, s84, 2
s_add_u32 s92, s92, s3
s_lshl_b32 s92, s92, 12
s_add_u32 s14, s92, 98304
s_mov_b32 s91, 0
L_lw_101:
ds_read_b32 v0, v5 offset:24
s_waitcnt lgkmcnt(0)
v_cmp_gt_u32 vcc, 1, v0
s_cbranch_vccz L_lwok_102
s_add_u32 s91, s91, 1
s_cmp_gt_u32 s91, 960000
s_cbranch_scc1 L_end
s_sleep 4
s_branch L_lw_101
L_lwok_102:
buffer_load_dwordx4 v[40:43], v39, s[64:67], s14 offen offset:0 sc1
buffer_load_dwordx4 v[44:47], v39, s[64:67], s14 offen offset:1024 sc1
buffer_load_dwordx4 v[48:51], v39, s[64:67], s14 offen offset:2048 sc1
buffer_load_dwordx4 v[52:55], v39, s[64:67], s14 offen offset:3072 sc1
s_waitcnt vmcnt(0)
s_mov_b32 s91, 0
L_retry_103:
v_max3_u32 v0, v40, v41, v42
v_max3_u32 v0, v0, v43, v44
v_max3_u32 v0, v0, v45, v46
v_max3_u32 v0, v0, v47, v48
v_max3_u32 v0, v0, v49, v50
v_max3_u32 v0, v0, v51, v52
v_max3_u32 v0, v0, v53, v54
v_max_u32 v0, v0, v55
v_cmp_eq_u32 vcc, -1, v0
s_cbranch_vccz L_ok_104
s_add_u32 s91, s91, 1
s_cmp_gt_u32 s91, 60000
s_cbranch_scc1 L_end
s_sleep 16
s_mov_b64 exec, vcc
buffer_load_dwordx4 v[40:43], v39, s[64:67], s14 offen offset:0 sc1
buffer_load_dwordx4 v[44:47], v39, s[64:67], s14 offen offset:1024 sc1
buffer_load_dwordx4 v[48:51], v39, s[64:67], s14 offen offset:2048 sc1
buffer_load_dwordx4 v[52:55], v39, s[64:67], s14 offen offset:3072 sc1
s_waitcnt vmcnt(0)
s_branch L_retry_103
L_ok_104:
s_mov_b64 exec, -1
v_add_f32 v40, v40, v44
v_add_f32 v41, v41, v45
v_add_f32 v42, v42, v46
v_add_f32 v43, v43, v47
s_nop 0
v_permlane32_swap_b32 v40, v42
v_permlane32_swap_b32 v41, v43
v_add_f32 v40, v40, v42
v_add_f32 v41, v41, v43
v_cvt_pk_bf16_f32 v40, v40, v41
ds_write_b32 v38, v40 offset:0
v_add_f32 v48, v48, v52
v_add_f32 v49, v49, v53
v_add_f32 v50, v50, v54
v_add_f32 v51, v51, v55
s_nop 0
v_permlane32_swap_b32 v48, v50
v_permlane32_swap_b32 v49, v51
v_add_f32 v48, v48, v50
v_add_f32 v49, v49, v51
v_cvt_pk_bf16_f32 v48, v48, v49
ds_write_b32 v38, v48 offset:272
s_waitcnt lgkmcnt(0)
s_mov_b64 exec, 1
ds_add_u32 v5, v6 offset:12
s_mov_b64 exec, -1
s_cmp_eq_u32 s51, 0
s_cbranch_scc1 L_nom12
s_cmp_lg_u32 s3, 0
s_cbranch_scc1 L_nored_105
s_mov_b32 s91, 0
L_lw_106:
ds_read_b32 v0, v5 offset:8
s_waitcnt lgkmcnt(0)
v_cmp_gt_u32 vcc, 4, v0
s_cbranch_vccz L_lwok_107
s_add_u32 s91, s91, 1
s_cmp_gt_u32 s91, 960000
s_cbranch_scc1 L_end
s_branch L_lw_106
L_pad3467:
s_branch L_pad2360
L_lwok_107:
v_add_u32 v2, 133120, v25
ds_read2st64_b64 v[12:15], v2 offset0:0 offset1:1
ds_read2st64_b64 v[16:19], v2 offset0:2 offset1:3
s_waitcnt lgkmcnt(0)
v_pk_add_f32 v[12:13], v[12:13], v[14:15]
v_pk_add_f32 v[16:17], v[16:17], v[18:19]
v_pk_add_f32 v[12:13], v[12:13], v[16:17]
v_min_u32 v12, -2, v12
v_min_u32 v13, -2, v13
s_nop 0
v_mov_b32_dpp v14, v12 quad_perm:[1,1,3,3] row_mask:0xf bank_mask:0xf
v_mov_b32_dpp v15, v13 quad_perm:[1,1,3,3] row_mask:0xf bank_mask:0xf
s_mov_b32 exec_lo, 0x55555555
s_mov_b32 exec_hi, 0x55555555
buffer_store_dwordx4 v[12:15], v25, s[64:67], s50 offen sc1
s_mov_b64 exec, -1
L_nored_105:
L_nom12:
s_cmp_eq_u32 s3, 2
s_cbranch_scc1 L_pad3644
L_warm_done:
s_cmp_lg_u32 s89, 0
s_cbranch_scc1 L_g0
s_lshl_b32 s92, s3, 3
s_add_u32 s92, s92, s88
s_lshl_b32 s92, s92, 11
s_add_u32 s14, s92, 770048
s_mov_b32 s91, 0
L_lw_108:
ds_read_b32 v0, v5 offset:16
s_waitcnt lgkmcnt(0)
v_cmp_gt_u32 vcc, 4, v0
s_cbranch_vccz L_lwok_109
s_add_u32 s91, s91, 1
s_cmp_gt_u32 s91, 960000
s_cbranch_scc1 L_end
s_sleep 8
s_branch L_lw_108
L_lwok_109:
buffer_load_dwordx4 v[56:59], v39, s[64:67], s14 offen offset:0 sc1
buffer_load_dwordx4 v[60:63], v39, s[64:67], s14 offen offset:1024 sc1
s_waitcnt vmcnt(0)
s_mov_b32 s91, 0
L_retry_110:
v_max3_u32 v0, v56, v57, v58
v_max3_u32 v0, v0, v59, v60
v_max3_u32 v0, v0, v61, v62
v_max_u32 v0, v0, v63
v_cmp_eq_u32 vcc, -1, v0
s_cbranch_vccz L_ok_111
s_add_u32 s91, s91, 1
s_cmp_gt_u32 s91, 60000
s_cbranch_scc1 L_end
s_sleep 16
s_mov_b64 exec, vcc
buffer_load_dwordx4 v[56:59], v39, s[64:67], s14 offen offset:0 sc1
buffer_load_dwordx4 v[60:63], v39, s[64:67], s14 offen offset:1024 sc1
s_waitcnt vmcnt(0)
s_branch L_retry_110
L_ok_111:
s_mov_b64 exec, -1
v_add_f32 v56, v56, v60
v_add_f32 v57, v57, v61
v_add_f32 v58, v58, v62
v_add_f32 v59, v59, v63
s_nop 0
v_permlane32_swap_b32 v56, v58
v_permlane32_swap_b32 v57, v59
v_add_f32 v56, v56, v58
v_add_f32 v57, v57, v59
v_cvt_pk_bf16_f32 v56, v56, v56
v_and_b32 v56, 0xffff0000, v56
v_cvt_pk_bf16_f32 v57, v57, v57
v_and_b32 v57, 0xffff0000, v57
s_cmp_lg_u32 s3, 2
s_cbranch_scc1 L_nocb
v_add_f32 v56, 1.0, v56
v_add_f32 v57, 1.0, v57
v_cvt_pk_bf16_f32 v56, v56, v56
v_and_b32 v56, 0xffff0000, v56
v_cvt_pk_bf16_f32 v57, v57, v57
v_and_b32 v57, 0xffff0000, v57
L_nocb:
ds_write_b64 v37, v[56:57]
s_cmp_lg_u32 s3, 0
s_cbranch_scc1 L_pool
s_lshr_b32 s92, s85, 3
s_lshl_b32 s92, s92, 3
s_add_u32 s92, s92, s87
s_lshl_b32 s92, s92, 11
s_add_u32 s19, s92, 901120
s_add_u32 s20, s19, 32768
s_mov_b32 s18, s19
s_lshl_b32 s14, s87, 7
s_add_u32 s14, s14, 1556480
v_lshlrev_b32 v20, 2, v1
s_waitcnt lgkmcnt(0)
s_barrier
buffer_load_dwordx4 v[40:43], v39, s[64:67], s18 offen offset:0 sc1
buffer_load_dwordx4 v[44:47], v39, s[64:67], s18 offen offset:1024 sc1
s_mov_b32 s91, 0
s_mov_b64 exec, 0xffff
L_hint:
buffer_load_dword v21, v20, s[64:67], s14 offen sc1
s_add_u32 s91, s91, 1
s_cmp_gt_u32 s91, 128
s_waitcnt vmcnt(0)
v_cmp_eq_u32 vcc, -1, v21
s_sleep 3
s_cbranch_scc1 L_hint_end
s_cbranch_vccnz L_hint
L_hint_end:
s_waitcnt lgkmcnt(0)
s_mov_b64 exec, 1
ds_add_u32 v5, v6 offset:44
s_mov_b64 exec, -1
s_barrier
buffer_load_dwordx4 v[40:43], v39, s[64:67], s18 offen offset:0 sc1
buffer_load_dwordx4 v[44:47], v39, s[64:67], s18 offen offset:1024 sc1
s_waitcnt vmcnt(0)
s_mov_b32 s91, 0
L_retry_112:
v_max3_u32 v0, v40, v41, v42
v_max3_u32 v0, v0, v43, v44
v_max3_u32 v0, v0, v45, v46
v_max_u32 v0, v0, v47
v_cmp_eq_u32 vcc, -1, v0
s_cbranch_vccz L_ok_113
s_add_u32 s91, s91, 1
s_cmp_gt_u32 s91, 60000
s_cbranch_scc1 L_end
s_and_b32 s18, s91, 127
s_cmp_eq_u32 s18, 0
s_cselect_b32 s18, s20, s19
s_mov_b64 exec, vcc
buffer_load_dwordx4 v[40:43], v39, s[64:67], s18 offen offset:0 sc1
buffer_load_dwordx4 v[44:47], v39, s[64:67], s18 offen offset:1024 sc1
s_waitcnt vmcnt(0)
s_branch L_retry_112
L_ok_113:
s_mov_b64 exec, -1
v_pk_add_f32 v[40:41], v[40:41], v[42:43]
v_pk_add_f32 v[44:45], v[44:45], v[46:47]
v_pk_add_f32 v[40:41], v[40:41], v[44:45]
s_nop 1
v_add_f32_dpp v40, v40, v40 quad_perm:[1,0,3,2] row_mask:0xf bank_mask:0xf
v_add_f32_dpp v41, v41, v41 quad_perm:[1,0,3,2] row_mask:0xf bank_mask:0xf
s_nop 0
v_add_f32_dpp v40, v40, v40 quad_perm:[2,3,0,1] row_mask:0xf bank_mask:0xf
v_add_f32_dpp v41, v41, v41 quad_perm:[2,3,0,1] row_mask:0xf bank_mask:0xf
s_nop 0
v_add_f32_dpp v40, v40, v40 row_ror:8 row_mask:0xf bank_mask:0xf
v_add_f32_dpp v41, v41, v41 row_ror:8 row_mask:0xf bank_mask:0xf
s_nop 0
v_add_f32_dpp v40, v40, v40 row_ror:4 row_mask:0xf bank_mask:0xf
v_add_f32_dpp v41, v41, v41 row_ror:4 row_mask:0xf bank_mask:0xf
s_nop 0
v_add_f32_dpp v40, v40, v40 row_bcast:15 row_mask:0xa bank_mask:0xf
v_add_f32_dpp v41, v41, v41 row_bcast:15 row_mask:0xa bank_mask:0xf
s_nop 0
v_add_f32_dpp v40, v40, v40 row_bcast:31 row_mask:0xc bank_mask:0xf
v_add_f32_dpp v41, v41, v41 row_bcast:31 row_mask:0xc bank_mask:0xf
v_mul_f32 v40, 0xba800000, v40
v_mul_f32 v41, 0x3a800000, v41
v_fma_f32 v41, -v40, v40, v41
v_max_f32 v41, 0, v41
v_add_f32 v41, 925353388, v41
v_rsq_f32 v41, v41
s_mov_b32 exec_lo, 0
s_mov_b32 exec_hi, 0x80000000
s_nop 0
ds_write_b64 v5, v[40:41] offset:512
s_mov_b64 exec, -1
s_waitcnt lgkmcnt(0)
s_barrier
s_branch L_chain_fin
L_pad3644:
s_branch L_pad3467
L_g0:
s_cmp_lg_u32 s3, 0
s_cbranch_scc1 L_pool
s_lshl_b32 s92, s87, 3
s_lshr_b32 s93, s85, 2
s_mul_i32 s93, s93, 2304
s_add_u32 s92, s92, s93
s_add_u32 s14, s92, 182272
v_mul_u32_u24 v20, 9216, v1
s_mov_b32 s91, 0
L_lw_114:
ds_read_b32 v0, v5 offset:28
s_waitcnt lgkmcnt(0)
v_cmp_gt_u32 vcc, 8, v0
s_cbranch_vccz L_lwok_115
s_add_u32 s91, s91, 1
s_cmp_gt_u32 s91, 960000
s_cbranch_scc1 L_end
s_sleep 8
s_branch L_lw_114
L_lwok_115:
buffer_load_dwordx2 v[22:23], v20, s[64:67], s14 offen sc1
s_barrier
s_waitcnt vmcnt(0)
s_mov_b32 s91, 0
L_retry_116:
v_max_u32 v0, v22, v23
v_cmp_eq_u32 vcc, -1, v0
s_cbranch_vccz L_ok_117
s_add_u32 s91, s91, 1
s_cmp_gt_u32 s91, 60000
s_cbranch_scc1 L_end
s_sleep 2
s_mov_b64 exec, vcc
buffer_load_dwordx2 v[22:23], v20, s[64:67], s14 offen sc1
s_waitcnt vmcnt(0)
s_branch L_retry_116
L_ok_117:
s_mov_b64 exec, -1
v_mov_b32 v16, v22
s_nop 1
v_max_f32_dpp v16, v16, v16 quad_perm:[1,0,3,2] row_mask:0xf bank_mask:0xf
s_nop 1
v_max_f32_dpp v16, v16, v16 quad_perm:[2,3,0,1] row_mask:0xf bank_mask:0xf
s_nop 1
v_max_f32_dpp v16, v16, v16 row_ror:8 row_mask:0xf bank_mask:0xf
s_nop 1
v_max_f32_dpp v16, v16, v16 row_ror:4 row_mask:0xf bank_mask:0xf
v_mov_b32 v17, v16
s_nop 1
v_permlane16_swap_b32 v17, v16
v_max_f32 v16, v16, v17
v_mov_b32 v17, v16
s_nop 1
v_permlane32_swap_b32 v17, v16
v_max_f32 v16, v16, v17
v_sub_f32 v22, v22, v16
v_mul_f32 v22, 1069066811, v22
v_exp_f32 v22, v22
s_nop 0
v_mul_f32 v23, v23, v22
s_nop 1
v_add_f32_dpp v23, v23, v23 quad_perm:[1,0,3,2] row_mask:0xf bank_mask:0xf
s_nop 1
v_add_f32_dpp v23, v23, v23 quad_perm:[2,3,0,1] row_mask:0xf bank_mask:0xf
s_nop 1
v_add_f32_dpp v23, v23, v23 row_ror:8 row_mask:0xf bank_mask:0xf
s_nop 1
v_add_f32_dpp v23, v23, v23 row_ror:4 row_mask:0xf bank_mask:0xf
v_mov_b32 v17, v23
s_nop 1
v_permlane16_swap_b32 v17, v23
v_add_f32 v23, v23, v17
v_mov_b32 v17, v23
s_nop 1
v_permlane32_swap_b32 v17, v23
v_add_f32 v23, v23, v17
v_rcp_f32 v23, v23
v_lshlrev_b32 v16, 2, v1
v_add_u32 v16, 138496, v16
v_mul_f32 v22, v22, v23
v_cvt_pk_bf16_f32 v23, v22, v22
v_and_b32 v23, 0xffff0000, v23
v_sub_f32 v23, v22, v23
v_cvt_pk_bf16_f32 v22, v22, v23
ds_write_b32 v16, v22
s_waitcnt lgkmcnt(0)
s_mov_b64 exec, 1
ds_add_u32 v5, v6 offset:32
s_mov_b64 exec, -1
s_branch L_chain_fin
L_pool:
s_nop 0
L_chain_fin:
s_waitcnt vmcnt(0) lgkmcnt(0)
s_endpgm
L_end:
s_waitcnt vmcnt(0) lgkmcnt(0)
s_endpgm
.section .rodata,"a"
.p2align 6
.amdhsa_kernel adaLN_cond__gqa_block_cached__swiglu_ffn__decode_kernel
  .amdhsa_next_free_vgpr 168
  .amdhsa_next_free_sgpr 102
  .amdhsa_accum_offset 168
  .amdhsa_group_segment_fixed_size 0
  .amdhsa_kernarg_size 112
  .amdhsa_user_sgpr_count 2
  .amdhsa_user_sgpr_kernarg_segment_ptr 1
  .amdhsa_system_sgpr_workgroup_id_x 1
.end_amdhsa_kernel
```
